```python
import torch

def _softmax(x, axis=-1):
    return torch.softmax(x, dim=axis)

def _gelu(x):
    return torch.nn.functional.gelu(x, approximate='tanh')

def _silu(x):
    return torch.nn.functional.silu(x)

def _sigmoid(x):
    return torch.sigmoid(x)

def _layernorm(x, axis=-1, eps=1e-05):
    m = x.mean(dim=axis, keepdim=True)
    v = x.var(dim=axis, keepdim=True, unbiased=False)
    return (x - m) / torch.sqrt(v + eps)

def _scatter_add(tgt, idx, src, axis=0):
    return tgt.clone().index_add_(axis, idx, src)

def _segment_sum(src, seg, n):
    out = torch.zeros((n,) + src.shape[1:], dtype=src.dtype)
    return out.index_add_(0, seg, src)

def _pad(x, pw):
    flat = tuple((v for pair in reversed(pw) for v in pair))
    return torch.nn.functional.pad(x, flat)
kernel_name = 'gather_scatter__tensor_product_equiv_tfn__graph'

def setup_inputs():

    _w = lambda a: (lambda t: t.to(torch.bfloat16) if t.is_floating_point() else t)(torch.as_tensor(a))
    N, deg, C, L, DE = (10000, 16, 128, 1, 4)
    E = N * deg
    M = (L + 1) ** 2
    src = (lambda lo, hi, *s: torch.randint(lo, hi, s))(0, N, E).to(torch.int64)
    dst = (lambda lo, hi, *s: torch.randint(lo, hi, s))(0, N, E).to(torch.int64)
    r = (lambda *s: torch.randn(*s, dtype=torch.bfloat16) * 0.05)(E, 3)
    r = r / (torch.linalg.norm(r, dim=-1, keepdim=True) + 1e-09)
    rx, ry, rz = (r[:, 0].clone(), r[:, 1].clone(), r[:, 2].clone())
    Ys = [torch.ones((E, 1), dtype=float)]
    if L >= 1:
        Ys.append(r.to(float))
    if L >= 2:
        Ys.append(torch.stack([2 * rx * ry, 2 * ry * rz, (3 * rz * rz - 1.0) / (lambda _x: torch.sqrt(torch.as_tensor(_x)))(3.0), 2 * rx * rz, rx * rx - ry * ry], dim=-1).to(float))
    for _l in range(3, L + 1):
        Ys.append(((lambda *s: torch.randn(*s, dtype=torch.bfloat16) * 0.05)(E, 2 * _l + 1) * 0.3).to(float))
    Y = torch.cat(Ys, dim=-1)
    cg = torch.zeros((M, M, M), dtype=float)
    off = [_l * _l for _l in range(L + 2)]
    for l1 in range(L + 1):
        for l2 in range(L + 1):
            for l3 in range(abs(l1 - l2), min(L, l1 + l2) + 1):
                d1, d2, d3 = (2 * l1 + 1, 2 * l2 + 1, 2 * l3 + 1)
                cg[off[l1]:off[l1 + 1], off[l2]:off[l2 + 1], off[l3]:off[l3 + 1]] = (lambda *s: torch.randn(*s, dtype=torch.bfloat16) * 0.05)(d1, d2, d3) / (lambda _x: torch.sqrt(torch.as_tensor(_x)))(float(d1 * d2))
    return {'x': _w((lambda *s: torch.randn(*s, dtype=torch.bfloat16) * 0.05)(N, C, M) * 0.2), 'src': _w(src), 'dst': _w(dst), 'Y': _w(Y), 'edge_feat': _w((lambda *s: torch.randn(*s, dtype=torch.bfloat16) * 0.05)(E, DE)), 'w_rad': _w((lambda *s: torch.randn(*s, dtype=torch.bfloat16) * 0.05)(DE, C) * (1.0 / max(1.0, DE) ** 0.5)), 'cg': _w(cg), 'w_mix': _w((lambda *s: torch.randn(*s, dtype=torch.bfloat16) * 0.05)(C, C) * (1.0 / max(1.0, C) ** 0.5))}

def reference(x, src, dst, Y, edge_feat, w_rad, cg, w_mix):
    N, C, M = (x.shape[0], x.shape[1], x.shape[2])
    R = _silu(edge_feat @ w_rad)
    xs = x[src]
    tp = torch.einsum('eci,ef,ifo->eco', xs, Y, cg)
    msg = R[:, :, None] * tp
    agg = _segment_sum(msg.reshape(-1, C * M), dst, N).reshape(N, C, M)
    return torch.einsum('ncm,cd->ndm', agg, w_mix)
```

```asm
; @launch grid=(256,1,1) block=(512,1,1) lds=158208
.amdgcn_target "amdgcn-amd-amdhsa--gfx950"
.text
.p2align 8
.globl gather_scatter__tensor_product_equiv_tfn__graph_kernel
.type gather_scatter__tensor_product_equiv_tfn__graph_kernel,@function
gather_scatter__tensor_product_equiv_tfn__graph_kernel:
    s_cmp_ge_u32 s2, 256
    s_cbranch_scc1 Lm_end
    s_load_dwordx16 s[4:19], s[0:1], 0
    s_load_dwordx2 s[28:29], s[0:1], 80
    s_load_dwordx2 s[24:25], s[0:1], 64
    s_getpc_b64 s[78:79]
La_pc:
    s_lshr_b32 s43, s2, 3
    s_mul_i32 s76, s43, 512
    s_sub_u32 s76, s76, 65024
    v_lshl_add_u32 v32, v0, 7, s76
    v_min_u32 v32, tfn_deal_table+508-La_pc, v32
    v_cmp_lt_u32 vcc, 507, v0
    s_and_saveexec_b64 s[80:81], vcc
    s_cbranch_execz La_notouch
    global_load_dword v15, v32, s[78:79]
La_notouch:
    s_mov_b64 exec, -1
    v_lshrrev_b32 v32, 6, v0
    v_and_b32 v2, 63, v0
    v_readfirstlane_b32 s33, v32
    v_mov_b32 v32, 0
    v_mov_b32 v33, 0
    v_lshlrev_b32 v39, 3, v0
    ds_write_b64 v39, v[32:33]
    v_lshlrev_b32 v1, 4, v2
    v_mov_b32 v6, 1
    s_mul_i32 s3, s2, 2560
    v_add_u32 v35, s3, v39
    v_lshlrev_b32 v36, 1, v35
    s_and_b32 s32, s2, 7
    s_lshl_b32 s32, s32, 5
    s_or_b32 s32, s32, s43
    v_lshlrev_b32 v14, 7, v0
    s_mov_b32 s22, 10240000
    s_mov_b32 s23, 0x20000
    s_mov_b32 s26, 10240000
    s_mov_b32 s27, 0x20000
    s_mov_b32 s34, 0
    v_mov_b32 v195, 565376
    v_mov_b32 v204, 560
    s_mov_b32 s86, 0xbf317218
    s_lshl_b32 s40, s2, 11
    v_lshl_add_u32 v38, v0, 4, s40
    s_cmp_lt_u32 s2, 250
    s_cselect_b32 s40, 5, 0
    s_cmp_lt_u32 s33, s40
    s_cselect_b32 s42, 1, 0
    s_waitcnt lgkmcnt(0)
    s_cbranch_scc0 La_noload
    global_load_dwordx2 v[88:89], v35, s[8:9]
La_noload:
    s_cmp_lg_u32 s33, 5
    s_cbranch_scc1 La_notag
    global_load_dword v195, v195, s[28:29] sc1
La_notag:
    s_add_u32 s30, s28, 524288
    s_addc_u32 s31, s29, 0
    s_mov_b32 s20, s4
    s_and_b32 s21, s5, 0xffff
    s_and_b32 s25, s25, 0xffff
    s_barrier
    s_cmp_eq_u32 s42, 0
    s_cbranch_scc1 La_other
    global_load_dwordx2 v[90:91], v35, s[6:7]
    global_load_dwordx4 v[92:95], v36, s[10:11]
    global_load_dwordx4 v[96:99], v36, s[12:13]
    s_barrier
    s_and_b32 s6, s2, 7
    s_sub_u32 s87, 8, s6
    s_lshl_b32 s87, s87, 5
    s_mul_i32 s6, s6, 1291264
    v_mov_b32 v152, 0
    v_mov_b32 v153, 0
    v_mov_b32 v154, 0
    v_mov_b32 v155, 0
    v_mov_b32 v156, 0
    v_mov_b32 v157, 0
    v_mov_b32 v158, 0
    v_mov_b32 v159, 0
    v_mov_b32 v160, 0
    v_mov_b32 v161, 0
    v_mov_b32 v162, 0
    v_mov_b32 v163, 0
    v_mov_b32 v164, 0
    v_mov_b32 v165, 0
    v_mov_b32 v166, 0
    v_mov_b32 v167, 0
    v_mov_b32 v168, 0
    v_mov_b32 v169, 0
    v_mov_b32 v170, 0
    v_mov_b32 v171, 0
    v_mov_b32 v172, 0
    v_mov_b32 v173, 0
    v_mov_b32 v174, 0
    v_mov_b32 v175, 0
    v_mov_b32 v176, 0
    v_mov_b32 v177, 0
    v_mov_b32 v178, 0
    v_mov_b32 v179, 0
    v_mov_b32 v180, 0
    v_mov_b32 v181, 0
    v_mov_b32 v182, 0
    v_mov_b32 v183, 0
    v_mov_b32 v184, 0
    v_mov_b32 v185, 0
    v_mov_b32 v186, 0
    v_mov_b32 v187, 0
    v_mov_b32 v188, 0
    v_mov_b32 v189, 0
    v_mov_b32 v190, 0
    v_mov_b32 v191, 0
    s_waitcnt vmcnt(3)
    v_bfe_u32 v100, v88, 3, 5
    v_and_b32 v32, 7, v88
    v_lshlrev_b32 v100, 2, v100
    v_lshl_or_b32 v100, v32, 7, v100
    ds_add_rtn_u32 v102, v100, v6 offset:1280
    v_bfe_u32 v101, v89, 3, 5
    v_and_b32 v33, 7, v89
    v_lshlrev_b32 v101, 2, v101
    v_lshl_or_b32 v101, v33, 7, v101
    ds_add_rtn_u32 v103, v101, v6 offset:1280
    v_bfe_u32 v104, v88, 8, 6
    v_bfe_u32 v106, v89, 8, 6
    s_waitcnt lgkmcnt(0)
    s_barrier
    ds_read_b128 v[108:111], v1 offset:1280
    ds_read_b32 v116, v204
    ds_read_b64 v[28:29], v39 offset:1280
    s_mov_b32 s40, 112128
    s_waitcnt lgkmcnt(2)
    v_add_u32 v32, v108, v109
    v_add_u32 v33, v32, v110
    v_add_u32 v34, v33, v111
    v_mov_b32 v35, v34
    s_nop 1
    v_add_u32_dpp v35, v35, v35 row_shr:1 row_mask:0xf bank_mask:0xf bound_ctrl:1
    s_nop 1
    v_add_u32_dpp v35, v35, v35 row_shr:2 row_mask:0xf bank_mask:0xf bound_ctrl:1
    s_nop 1
    v_add_u32_dpp v35, v35, v35 row_shr:4 row_mask:0xf bank_mask:0xf bound_ctrl:1
    s_nop 1
    v_add_u32_dpp v35, v35, v35 row_shr:8 row_mask:0xf bank_mask:0xf bound_ctrl:1
    s_nop 1
    v_add_u32_dpp v35, v35, v35 row_bcast:15 row_mask:0xa bank_mask:0xf
    s_nop 1
    v_add_u32_dpp v35, v35, v35 row_bcast:31 row_mask:0xc bank_mask:0xf
    v_sub_u32 v112, v35, v34
    v_add_u32 v113, v112, v108
    v_add_u32 v114, v112, v32
    v_add_u32 v115, v112, v33
    ds_write_b128 v1, v[112:115] offset:2304
    ds_read_b64 v[30:31], v39 offset:2304
    ds_read_b32 v32, v100 offset:2304
    ds_read_b32 v33, v101 offset:2304
    s_waitcnt lgkmcnt(4)
    v_readfirstlane_b32 s41, v116
    v_mov_b32 v117, v116
    v_mov_b32 v105, v116
    v_mov_b32 v107, v116
    v_mov_b32 v25, v116
    v_mov_b32 v27, v116
    s_cmp_ge_u32 s33, 2
    s_cbranch_scc1 La_notab
    s_waitcnt lgkmcnt(2)
    v_lshl_or_b32 v24, v28, 16, v30
    v_lshl_or_b32 v26, v29, 16, v31
    global_store_dwordx4 v38, v[24:27], s[28:29] sc1
    s_waitcnt vmcnt(3) lgkmcnt(0)
    v_mul_u32_u24 v36, 13, v90
    v_lshl_or_b32 v104, v90, 10, v104
    v_lshrrev_b32 v36, 11, v36
    v_add_u32 v102, v102, v32
    v_lshl_or_b32 v104, v36, 24, v104
    v_lshl_add_u32 v102, v102, 4, s40
    v_add_u32 v100, 10240, v102
    v_mul_u32_u24 v36, 13, v91
    v_lshl_or_b32 v106, v91, 10, v106
    v_lshrrev_b32 v36, 11, v36
    v_add_u32 v103, v103, v33
    v_lshl_or_b32 v106, v36, 24, v106
    v_lshl_add_u32 v103, v103, 4, s40
    v_add_u32 v101, 10240, v103
    s_waitcnt vmcnt(2)
    s_branch La_tabdone
La_notab:
    s_waitcnt vmcnt(2) lgkmcnt(0)
    v_mul_u32_u24 v36, 13, v90
    v_lshl_or_b32 v104, v90, 10, v104
    v_lshrrev_b32 v36, 11, v36
    v_add_u32 v102, v102, v32
    v_lshl_or_b32 v104, v36, 24, v104
    v_lshl_add_u32 v102, v102, 4, s40
    v_add_u32 v100, 10240, v102
    v_mul_u32_u24 v36, 13, v91
    v_lshl_or_b32 v106, v91, 10, v106
    v_lshrrev_b32 v36, 11, v36
    v_add_u32 v103, v103, v33
    v_lshl_or_b32 v106, v36, 24, v106
    v_lshl_add_u32 v103, v103, 4, s40
    v_add_u32 v101, 10240, v103
    s_waitcnt vmcnt(1)
La_tabdone:
    ds_write2_b64 v102, v[104:105], v[92:93] offset0:0 offset1:1
    ds_write2_b64 v103, v[106:107], v[94:95] offset0:0 offset1:1
La_join:
    s_mov_b32 s40, 112128
    v_lshl_add_u32 v36, v0, 4, s40
    s_mul_i32 s40, s2, 20608
    v_lshl_add_u32 v37, v0, 4, s40
    v_add_u32 v38, 8192, v37
    v_add_u32 v7, 10240, v37
    v_add_u32 v8, 18432, v37
    s_waitcnt lgkmcnt(0)
    s_barrier
    s_cmp_ge_u32 s2, 250
    s_cbranch_scc1 La_nostore
    ds_read_b128 v[92:95], v36
    s_cmp_lt_u32 s33, 2
    s_cbranch_scc1 La_four
    s_waitcnt lgkmcnt(0)
    global_store_dwordx4 v37, v[92:95], s[30:31] sc1
    s_cmp_ge_u32 s33, 5
    s_cbranch_scc1 La_nog1
    s_waitcnt vmcnt(1)
    ds_write2_b64 v100, v[96:97], v[116:117] offset0:0 offset1:1
    ds_write2_b64 v101, v[98:99], v[116:117] offset0:0 offset1:1
    s_waitcnt lgkmcnt(0)
La_nog1:
    s_barrier
    ds_read_b128 v[196:199], v36 offset:10240
    s_waitcnt lgkmcnt(0)
    global_store_dwordx4 v7, v[196:199], s[30:31] sc1
    s_branch La_nostore
La_four:
    ds_read_b128 v[108:111], v36 offset:8192
    s_waitcnt lgkmcnt(1)
    global_store_dwordx4 v37, v[92:95], s[30:31] sc1
    s_waitcnt lgkmcnt(0)
    global_store_dwordx4 v38, v[108:111], s[30:31] sc1
    s_waitcnt vmcnt(3)
    ds_write2_b64 v100, v[96:97], v[116:117] offset0:0 offset1:1
    ds_write2_b64 v101, v[98:99], v[116:117] offset0:0 offset1:1
    s_waitcnt lgkmcnt(0)
    s_barrier
    ds_read_b128 v[196:199], v36 offset:10240
    ds_read_b128 v[200:203], v36 offset:18432
    s_waitcnt lgkmcnt(1)
    global_store_dwordx4 v7, v[196:199], s[30:31] sc1
    s_waitcnt lgkmcnt(0)
    global_store_dwordx4 v8, v[200:203], s[30:31] sc1
La_nostore:
    s_getpc_b64 s[78:79]
Lm_pc:
    s_cmp_lt_u32 s2, 16
    s_cselect_b32 s40, 256, 0
    s_add_u32 s40, s40, tfn_deal_table-Lm_pc
    v_lshl_add_u32 v32, v2, 2, s40
    global_load_dword v193, v32, s[78:79]
    s_lshl_b32 s40, s32, 3
    v_lshrrev_b32 v34, 1, v0
    v_lshl_add_u32 v35, v34, 11, s40
    global_load_dwordx2 v[28:29], v35, s[28:29] sc1
    v_mul_u32_u24 v4, 20608, v34
    s_cmp_ge_u32 s33, 5
    s_cbranch_scc1 Lm_wmside
Lm_wmback:
    v_and_b32 v36, 1, v0
    v_mov_b32 v37, 512
    v_lshlrev_b32 v3, 4, v0
    v_add_u32 v3, 38400, v3
    s_mov_b32 s3, 65536
    s_mov_b32 s7, 5
    v_lshrrev_b32 v204, 2, v2
    v_lshlrev_b32 v204, 3, v204
    v_bfe_u32 v32, v2, 3, 2
    v_and_b32 v33, 3, v2
    v_lshl_add_u32 v32, v32, 2, v33
    v_lshlrev_b32 v195, 3, v32
    s_mov_b32 s78, 0x0f0f0f0f
    s_mov_b32 s79, 0xf0f0f0f0
    v_mov_b32 v32, 128
    v_cndmask_b32 v10, 0, v32, s[78:79]
    s_mul_i32 s40, s33, 4608
    s_add_u32 s40, s40, 112128
    v_lshl_add_u32 v205, v2, 2, s40
    v_and_b32 v32, 15, v2
    v_mul_u32_u24 v32, 288, v32
    v_and_b32 v33, 48, v2
    v_add3_u32 v206, v32, v33, s40
Lm_poll:
    s_waitcnt vmcnt(0)
Lm_poll2:
    v_cmp_ne_u32 vcc, s41, v29
    s_cbranch_vccnz Lm_repoll
    s_mov_b64 exec, -1
    v_and_b32 v32, 0xffff, v28
    v_lshrrev_b32 v33, 16, v28
    v_add_u32 v32, v32, v36
    v_sub_u32 v5, v33, v36
    v_lshl_add_u32 v4, v32, 4, v4
Lm_round:
    v_cmp_lt_i32 s[60:61], 0, v5
    v_cmp_lt_i32 s[62:63], 2, v5
    v_cmp_lt_i32 s[64:65], 4, v5
    v_cmp_lt_i32 s[66:67], 6, v5
    v_cmp_lt_i32 s[68:69], 8, v5
Lm_g0:
    s_mov_b64 exec, s[60:61]
    global_load_dwordx4 v[88:91], v4, s[30:31] offset:0 sc1
    s_mov_b64 exec, s[62:63]
    global_load_dwordx4 v[92:95], v4, s[30:31] offset:32 sc1
    s_mov_b64 exec, s[64:65]
    global_load_dwordx4 v[96:99], v4, s[30:31] offset:64 sc1
    s_mov_b64 exec, s[66:67]
    s_cbranch_execz Lm_ld
    global_load_dwordx4 v[100:103], v4, s[30:31] offset:96 sc1
    s_cmp_lg_u64 s[68:69], 0
    s_cbranch_scc1 Lm_ldx
Lm_ld:
    s_mov_b64 exec, -1
    v_add_u32 v192, 10240, v4
    s_cmp_lg_u32 s34, 0
    s_cbranch_scc1 Lm_nomax
    v_add_u32 v33, v5, v36
    v_cmp_lt_u32 vcc, 16, v33
    s_and_saveexec_b64 s[78:79], vcc
    ds_max_u32 v37, v33
    s_mov_b64 exec, -1
Lm_nomax:
    s_mov_b64 s[8:9], 0
    s_mov_b64 vcc, 0
    s_waitcnt vmcnt(0)
    s_mov_b64 exec, s[60:61]
    v_cmp_ne_u32 vcc, s41, v89
    v_and_b32 v128, 63, v88
    v_lshlrev_b32 v128, 2, v128
    s_or_b64 s[8:9], s[8:9], vcc
    s_mov_b64 exec, s[62:63]
    v_cmp_ne_u32 vcc, s41, v93
    v_and_b32 v129, 63, v92
    v_lshlrev_b32 v129, 2, v129
    s_or_b64 s[8:9], s[8:9], vcc
    s_mov_b64 exec, s[64:65]
    v_cmp_ne_u32 vcc, s41, v97
    v_and_b32 v130, 63, v96
    v_lshlrev_b32 v130, 2, v130
    s_or_b64 s[8:9], s[8:9], vcc
    s_mov_b64 exec, s[66:67]
    s_cbranch_execz Lm_ck0
    v_cmp_ne_u32 vcc, s41, v101
    v_and_b32 v131, 63, v100
    v_lshlrev_b32 v131, 2, v131
    s_or_b64 s[8:9], s[8:9], vcc
    s_cmp_lg_u64 s[68:69], 0
    s_cbranch_scc1 Lm_ck0x
Lm_ck0:
    s_mov_b64 exec, -1
    s_cmp_lg_u64 s[8:9], 0
    s_cbranch_scc1 Lm_re0
    s_mov_b64 exec, s[60:61]
    ds_add_u32 v128, v6 offset:0
    global_load_dwordx3 v[56:58], v192, s[30:31] offset:0 sc1
    ds_write_b64 v3, v[90:91] offset:0
    v_lshrrev_b32 v136, 22, v88
    v_add_u32 v136, s87, v136
    v_and_b32 v88, 0x00fffc00, v88
    s_mov_b64 exec, s[62:63]
    ds_add_u32 v129, v6 offset:0
    global_load_dwordx3 v[60:62], v192, s[30:31] offset:32 sc1
    ds_write_b64 v3, v[94:95] offset:8192
    v_lshrrev_b32 v137, 22, v92
    v_add_u32 v137, s87, v137
    v_and_b32 v92, 0x00fffc00, v92
    s_mov_b64 exec, s[64:65]
    ds_add_u32 v130, v6 offset:0
    global_load_dwordx3 v[64:66], v192, s[30:31] offset:64 sc1
    ds_write_b64 v3, v[98:99] offset:16384
    v_lshrrev_b32 v138, 22, v96
    v_add_u32 v138, s87, v138
    v_and_b32 v96, 0x00fffc00, v96
    s_mov_b64 exec, s[66:67]
    s_cbranch_execz Lm_h1
    ds_add_u32 v131, v6 offset:0
    global_load_dwordx3 v[68:70], v192, s[30:31] offset:96 sc1
    ds_write_b64 v3, v[102:103] offset:24576
    v_lshrrev_b32 v139, 22, v100
    v_add_u32 v139, s87, v139
    v_and_b32 v100, 0x00fffc00, v100
    s_cmp_lg_u64 s[68:69], 0
    s_cbranch_scc1 Lm_h1x
Lm_h1:
    s_mov_b64 exec, -1
    s_cmp_lg_u32 s34, 0
    s_cbranch_scc1 Lm_bins
    v_lshlrev_b32 v33, 2, v2
    s_mul_i32 s40, s33, 5
    v_sub_u32 v34, 63, v2
    v_add_u32 v38, s40, v2
    v_lshlrev_b32 v36, 2, v38
    v_and_b32 v39, 3, v0
    v_lshlrev_b32 v39, 5, v39
    s_add_u32 s76, s40, 1
    s_add_u32 s77, s40, 2
    s_add_u32 s78, s40, 3
    s_add_u32 s79, s40, 4
    s_waitcnt lgkmcnt(0)
    s_barrier
    ds_read_b32 v32, v33 offset:0
    ds_read_b32 v37, v37
    s_mul_i32 s80, s43, 32768
    s_add_u32 s80, s80, 262144
    s_add_u32 s80, s80, s6
    s_cmp_lt_u32 s33, 4
    s_cselect_b32 s80, s80, 10240000
    v_add_u32 v194, s80, v14
    buffer_load_dword v15, v194, s[20:23], 0 offen
    s_waitcnt lgkmcnt(0)
    v_lshl_or_b32 v32, v32, 6, v34
    v_readfirstlane_b32 s35, v37
    v_readlane_b32 s44, v32, s40
    v_readlane_b32 s45, v32, s76
    v_readlane_b32 s46, v32, s77
    v_readlane_b32 s47, v32, s78
    v_readlane_b32 s48, v32, s79
    v_cmp_lt_u32 s[76:77], s44, v32
    v_cmp_lt_u32 s[78:79], s45, v32
    v_cmp_lt_u32 s[80:81], s46, v32
    v_cmp_lt_u32 s[82:83], s47, v32
    v_cmp_lt_u32 s[84:85], s48, v32
    s_bcnt1_i32_b64 s52, s[76:77]
    s_bcnt1_i32_b64 s53, s[78:79]
    s_bcnt1_i32_b64 s54, s[80:81]
    s_bcnt1_i32_b64 s55, s[82:83]
    s_bcnt1_i32_b64 s56, s[84:85]
    v_readlane_b32 s44, v193, s52
    v_readlane_b32 s45, v193, s53
    v_readlane_b32 s46, v193, s54
    v_readlane_b32 s47, v193, s55
    v_readlane_b32 s48, v193, s56
    v_writelane_b32 v34, s44, 0
    v_writelane_b32 v34, s45, 1
    v_writelane_b32 v34, s46, 2
    v_writelane_b32 v34, s47, 3
    v_writelane_b32 v34, s48, 4
    s_mov_b64 exec, 31
    v_lshrrev_b32 v35, 24, v34
    ds_write_b32 v36, v34 offset:768
    ds_write_b32 v35, v38 offset:1024
    s_mov_b64 exec, -1
    ds_read_b128 v[40:43], v1 offset:3584
    ds_read_b128 v[44:47], v1 offset:4608
    ds_read_b128 v[48:51], v39 offset:3328
    ds_read_b128 v[52:55], v39 offset:3344
    s_waitcnt lgkmcnt(4)
    s_barrier
Lm_bins:
    s_mov_b64 exec, s[60:61]
    ds_read_b32 v144, v128 offset:768
    s_mov_b64 exec, s[62:63]
    ds_read_b32 v145, v129 offset:768
    s_mov_b64 exec, s[64:65]
    ds_read_b32 v146, v130 offset:768
    s_mov_b64 exec, s[66:67]
    s_cbranch_execz Lm_mp
    ds_read_b32 v147, v131 offset:768
    s_cmp_lg_u64 s[68:69], 0
    s_cbranch_scc1 Lm_mpx
Lm_mp:
    s_mov_b64 exec, -1
    s_waitcnt lgkmcnt(7)
    ds_bpermute_b32 v136, v136, v193
    ds_bpermute_b32 v137, v137, v193
    ds_bpermute_b32 v138, v138, v193
    ds_bpermute_b32 v139, v139, v193
    s_cmp_lg_u64 s[68:69], 0
    s_cbranch_scc1 Lm_sbx
Lm_sb:
    v_lshlrev_b32 v33, 2, v2
    s_lshl_b32 s40, s33, 3
    s_add_u32 s76, s40, 7
    v_lshrrev_b32 v35, 3, v2
    s_mov_b64 s[8:9], 0
    s_waitcnt lgkmcnt(0)
    s_mov_b64 exec, s[60:61]
    v_lshrrev_b32 v136, v144, v136
    v_and_b32 v128, 0xe0, v144
    v_and_or_b32 v128, v136, 28, v128
    ds_add_rtn_u32 v136, v128, v6 offset:256
    v_bfe_u32 v144, v144, 16, 8
    v_or_b32 v88, v88, v144
    v_add_u32 v89, 0, v3
    s_mov_b64 exec, s[62:63]
    v_lshrrev_b32 v137, v145, v137
    v_and_b32 v129, 0xe0, v145
    v_and_or_b32 v129, v137, 28, v129
    ds_add_rtn_u32 v137, v129, v6 offset:256
    v_bfe_u32 v145, v145, 16, 8
    v_or_b32 v92, v92, v145
    v_add_u32 v93, 8192, v3
    s_mov_b64 exec, s[64:65]
    v_lshrrev_b32 v138, v146, v138
    v_and_b32 v130, 0xe0, v146
    v_and_or_b32 v130, v138, 28, v130
    ds_add_rtn_u32 v138, v130, v6 offset:256
    v_bfe_u32 v146, v146, 16, 8
    v_or_b32 v96, v96, v146
    v_add_u32 v97, 16384, v3
    s_mov_b64 exec, s[66:67]
    s_cbranch_execz Lm_h2
    v_lshrrev_b32 v139, v147, v139
    v_and_b32 v131, 0xe0, v147
    v_and_or_b32 v131, v139, 28, v131
    ds_add_rtn_u32 v139, v131, v6 offset:256
    v_bfe_u32 v147, v147, 16, 8
    v_or_b32 v100, v100, v147
    v_add_u32 v101, 24576, v3
    s_cmp_lg_u64 s[68:69], 0
    s_cbranch_scc1 Lm_h2x
Lm_h2:
    s_mov_b64 exec, -1
    s_waitcnt lgkmcnt(0)
    s_barrier
    ds_read_b32 v32, v33 offset:256
    v_mov_b32 v36, 10240000
    v_mov_b32 v37, 528
    s_mov_b32 s78, 103936
    v_mov_b32 v38, 544
    s_mov_b32 s80, 0x0f0f0f0f
    s_mov_b32 s81, 0xf0f0f0f0
    v_mov_b32 v39, 512
    s_waitcnt lgkmcnt(0)
    v_mov_b32 v34, v32
    s_nop 1
    v_add_u32_dpp v34, v34, v34 row_shr:1 row_mask:0xf bank_mask:0xf bound_ctrl:1
    s_nop 1
    v_add_u32_dpp v34, v34, v34 row_shr:2 row_mask:0xf bank_mask:0xf bound_ctrl:1
    s_nop 1
    v_add_u32_dpp v34, v34, v34 row_shr:4 row_mask:0xf bank_mask:0xf bound_ctrl:1
    s_nop 1
    v_add_u32_dpp v34, v34, v34 row_shr:8 row_mask:0xf bank_mask:0xf bound_ctrl:1
    s_nop 1
    v_add_u32_dpp v34, v34, v34 row_bcast:15 row_mask:0xa bank_mask:0xf
    s_nop 1
    v_add_u32_dpp v34, v34, v34 row_bcast:31 row_mask:0xc bank_mask:0xf
    v_lshl_add_u32 v34, v35, 4, v34
    v_sub_u32 v32, v34, v32
    ds_bpermute_b32 v144, v128, v32
    ds_bpermute_b32 v145, v129, v32
    ds_bpermute_b32 v146, v130, v32
    ds_bpermute_b32 v147, v131, v32
    s_cmp_lg_u64 s[68:69], 0
    s_cbranch_scc1 Lm_bpx
Lm_bp:
    s_waitcnt vmcnt(1) lgkmcnt(6)
    s_cmp_lg_u32 s34, 0
    s_cbranch_scc1 Lm_g1w
Lm_g1:
    s_mov_b64 exec, s[60:61]
    v_cmp_ne_u32 vcc, s41, v58
    ds_write_b64 v3, v[56:57] offset:8
    s_or_b64 s[8:9], s[8:9], vcc
    s_mov_b64 exec, s[62:63]
    v_cmp_ne_u32 vcc, s41, v62
    ds_write_b64 v3, v[60:61] offset:8200
    s_or_b64 s[8:9], s[8:9], vcc
    s_mov_b64 exec, s[64:65]
    v_cmp_ne_u32 vcc, s41, v66
    ds_write_b64 v3, v[64:65] offset:16392
    s_or_b64 s[8:9], s[8:9], vcc
    s_mov_b64 exec, s[66:67]
    s_cbranch_execz Lm_ck1
    v_cmp_ne_u32 vcc, s41, v70
    ds_write_b64 v3, v[68:69] offset:24584
    s_or_b64 s[8:9], s[8:9], vcc
    s_cmp_lg_u64 s[68:69], 0
    s_cbranch_scc1 Lm_ck1x
Lm_ck1:
    s_mov_b64 exec, -1
    s_cmp_lg_u64 s[8:9], 0
    s_cbranch_scc1 Lm_re1
    v_readlane_b32 s36, v32, s40
    v_readlane_b32 s37, v34, s76
    v_readlane_b32 s42, v34, 63
    v_readlane_b32 s7, v32, s76
    v_add_u32 v34, s37, v2
    v_lshl_add_u32 v34, v34, 3, s78
    s_cmp_eq_u32 s33, 7
    s_cselect_b64 exec, -1, 0xffff
    ds_write_b64 v34, v[36:37]
    s_mov_b64 exec, -1
    s_sub_u32 s37, s37, s36
    s_sub_u32 s7, s7, s36
    s_lshl_b32 s36, s36, 3
    s_add_u32 s36, s36, 103936
    s_waitcnt lgkmcnt(1)
    s_mov_b64 exec, s[60:61]
    v_add_u32 v136, v136, v144
    v_lshl_add_u32 v136, v136, 3, s78
    ds_write_b64 v136, v[88:89]
    s_mov_b64 exec, s[62:63]
    v_add_u32 v137, v137, v145
    v_lshl_add_u32 v137, v137, 3, s78
    ds_write_b64 v137, v[92:93]
    s_mov_b64 exec, s[64:65]
    v_add_u32 v138, v138, v146
    v_lshl_add_u32 v138, v138, 3, s78
    ds_write_b64 v138, v[96:97]
    s_mov_b64 exec, s[66:67]
    s_cbranch_execz Lm_wr
    v_add_u32 v139, v139, v147
    v_lshl_add_u32 v139, v139, 3, s78
    ds_write_b64 v139, v[100:101]
    s_cmp_lg_u64 s[68:69], 0
    s_cbranch_scc1 Lm_wrx
Lm_wr:
    s_mov_b64 exec, -1
    v_lshl_add_u32 v7, v2, 3, s36
    v_add_u32 v9, s36, v204
    v_add_u32 v8, s36, v195
    v_cndmask_b32 v32, v38, v8, s[80:81]
    v_cndmask_b32 v8, v39, v8, s[80:81]
    v_mov_b32 v36, 0
    s_add_u32 s37, s37, 1
    s_lshr_b32 s37, s37, 1
    s_add_u32 s34, s34, 16
    s_waitcnt lgkmcnt(0)
    s_barrier
    ds_read_b32 v35, v7
    ds_read_b32 v34, v32 offset:4
    ds_read_b32 v12, v8 offset:36
    ds_read_b32 v13, v9 offset:4
    ds_read_b32 v11, v7 offset:48
    ds_write_b32 v33, v36 offset:256
    s_waitcnt lgkmcnt(5)
    v_readlane_b32 s44, v35, 0
    v_readlane_b32 s45, v35, 1
    v_readlane_b32 s46, v35, 2
    v_readlane_b32 s47, v35, 3
    v_readlane_b32 s48, v35, 4
    v_readlane_b32 s49, v35, 5
    v_readlane_b32 s50, v35, 6
    v_readlane_b32 s51, v35, 7
    s_and_b32 s38, s44, 0xfffffc00
    buffer_load_dwordx4 v[88:91], v1, s[20:23], s38 offen
    s_and_b32 s38, s45, 0xfffffc00
    buffer_load_dwordx4 v[92:95], v1, s[20:23], s38 offen
    s_and_b32 s38, s46, 0xfffffc00
    buffer_load_dwordx4 v[96:99], v1, s[20:23], s38 offen
    s_and_b32 s38, s47, 0xfffffc00
    buffer_load_dwordx4 v[100:103], v1, s[20:23], s38 offen
    s_and_b32 s38, s48, 0xfffffc00
    buffer_load_dwordx4 v[104:107], v1, s[20:23], s38 offen
    s_and_b32 s38, s49, 0xfffffc00
    buffer_load_dwordx4 v[108:111], v1, s[20:23], s38 offen
    s_waitcnt lgkmcnt(2)
    ds_read2_b64 v[56:59], v34 offset0:1 offset1:1
    ds_read_b64 v[20:21], v13
    ds_read2_b64 v[16:19], v12 offset0:1 offset1:1
    s_and_b32 s38, s50, 0xfffffc00
    s_and_b32 s39, s51, 0xfffffc00
    s_add_u32 s78, s33, 1
    s_and_b32 s78, s78, 3
    s_lshl_b32 s79, s78, 13
    v_add_u32 v36, s79, v1
    s_lshl_b32 s76, s33, 4
    s_and_b32 s77, s33, 4
    s_lshl_b32 s77, s77, 2
    v_lshrrev_b32 v33, 4, v2
    v_lshl_add_u32 v34, v33, 2, s76
    v_lshl_add_u32 v37, v33, 2, s77
    s_waitcnt lgkmcnt(0)
    ds_read_b32 v196, v34 offset:1024
    ds_read_b32 v197, v37 offset:1152
    ds_read_b128 v[208:211], v36 offset:5632
    ds_read_b128 v[212:215], v36 offset:6656
    ds_read_b128 v[216:219], v36 offset:7680
    ds_read_b128 v[220:223], v36 offset:8704
    ds_read_b128 v[224:227], v36 offset:9728
    ds_read_b128 v[228:231], v36 offset:10752
    ds_read_b128 v[232:235], v36 offset:11776
    ds_read_b128 v[236:239], v36 offset:12800
    v_and_b32 v35, 15, v2
    s_lshl_b32 s40, s2, 10
    v_lshl_add_u32 v35, v35, 4, s40
    s_add_u32 s76, s33, 1
    s_and_b32 s76, s76, 3
    s_lshl_b32 s40, s76, 13
    s_lshl_b32 s76, s76, 8
    s_add_u32 s77, s33, 2
    s_and_b32 s77, s77, 3
    s_lshl_b32 s40, s77, 13
    s_lshl_b32 s77, s77, 8
    v_add_u32 v37, s40, v1
    s_add_u32 s78, s33, 3
    s_and_b32 s78, s78, 3
    s_lshl_b32 s40, s78, 13
    s_lshl_b32 s78, s78, 8
    v_add_u32 v38, s40, v1
    s_add_u32 s79, s33, 4
    s_and_b32 s79, s79, 3
    s_lshl_b32 s40, s79, 13
    s_lshl_b32 s79, s79, 8
    v_add_u32 v39, s40, v1
    s_cmp_eq_u32 s37, 0
    s_cbranch_scc1 Lm_done
    v_mfma_f32_32x32x16_bf16 v[120:135], v[56:59], v[40:43], 0
    v_mfma_f32_32x32x16_bf16 v[136:151], v[56:59], v[44:47], 0
    v_dot2_f32_bf16 v24, v20, v48, 0
    v_dot2_f32_bf16 v25, v20, v50, 0
    v_dot2_f32_bf16 v26, v20, v52, 0
    v_dot2_f32_bf16 v27, v20, v54, 0
    v_dot2_f32_bf16 v24, v21, v49, v24
    v_dot2_f32_bf16 v25, v21, v51, v25
    v_dot2_f32_bf16 v26, v21, v53, v26
    v_dot2_f32_bf16 v27, v21, v55, v27
    v_add_u32 v8, v10, v8
    v_add_u32 v9, 128, v9
    v_add_u32 v7, 128, v7
    v_cvt_pk_bf16_f32 v22, v24, v25
    v_cvt_pk_bf16_f32 v23, v26, v27
    v_exp_f32 v64, v120
    v_exp_f32 v65, v121
    v_exp_f32 v66, v122
    v_exp_f32 v67, v123
    v_exp_f32 v68, v136
    v_exp_f32 v69, v137
    v_exp_f32 v70, v138
    v_exp_f32 v71, v139
    s_nop 0
    v_pk_add_f32 v[64:65], v[64:65], 1.0 op_sel_hi:[1,0]
    v_pk_add_f32 v[66:67], v[66:67], 1.0 op_sel_hi:[1,0]
    v_pk_add_f32 v[68:69], v[68:69], 1.0 op_sel_hi:[1,0]
    v_pk_add_f32 v[70:71], v[70:71], 1.0 op_sel_hi:[1,0]
    v_rcp_f32 v64, v64
    v_rcp_f32 v65, v65
    v_rcp_f32 v66, v66
    v_rcp_f32 v67, v67
    v_rcp_f32 v68, v68
    v_rcp_f32 v69, v69
    v_rcp_f32 v70, v70
    v_rcp_f32 v71, v71
    s_nop 0
    v_pk_mul_f32 v[72:73], v[120:121], v[64:65]
    v_pk_mul_f32 v[74:75], v[122:123], v[66:67]
    v_pk_mul_f32 v[76:77], v[136:137], v[68:69]
    v_pk_mul_f32 v[78:79], v[138:139], v[70:71]
    v_mfma_f32_32x32x16_bf16 v[120:135], v[16:19], v[40:43], 0
    s_nop 7
    s_setprio 1
    s_cmp_lt_u32 s33, 4
    s_cbranch_scc1 Lm_yp
    s_setprio 2
Lm_yp:
    s_cmp_lt_u32 s37, 8
    s_cbranch_scc1 Lm_tail
.p2align 6
Lm_loop:
    s_waitcnt vmcnt(4)
    buffer_load_dwordx4 v[112:115], v1, s[20:23], s38 offen
    buffer_load_dwordx4 v[116:119], v1, s[20:23], s39 offen
    v_mfma_f32_4x4x4_16b_bf16 v[56:59], v[22:23], v[88:89], 0 cbsz:4 abid:0
    v_exp_f32 v28, v120
    v_mfma_f32_4x4x4_16b_bf16 v[60:63], v[22:23], v[90:91], 0 cbsz:4 abid:0
    v_exp_f32 v29, v121
    v_mfma_f32_4x4x4_16b_bf16 v[64:67], v[22:23], v[92:93], 0 cbsz:4 abid:1
    v_exp_f32 v30, v122
    v_mfma_f32_4x4x4_16b_bf16 v[68:71], v[22:23], v[94:95], 0 cbsz:4 abid:1
    v_exp_f32 v31, v123
    s_waitcnt lgkmcnt(0)
    v_readlane_b32 s52, v11, 2
    v_readlane_b32 s53, v11, 3
    v_pk_add_f32 v[28:29], v[28:29], 1.0 op_sel_hi:[1,0]
    v_pk_add_f32 v[30:31], v[30:31], 1.0 op_sel_hi:[1,0]
    v_mfma_f32_32x32x16_bf16 v[136:151], v[16:19], v[44:47], 0
    v_rcp_f32 v28, v28
    v_rcp_f32 v29, v29
    v_rcp_f32 v30, v30
    v_rcp_f32 v31, v31
    ds_read_b32 v13, v9 offset:4
    ds_read_b32 v12, v8 offset:36
    s_and_b32 s38, s52, 0xfffffc00
    s_and_b32 s39, s53, 0xfffffc00
    s_set_gpr_idx_on s44, 0xc
    v_pk_fma_f32 v[152:153], v[72:73], v[56:57], v[152:153] op_sel:[0,0,0] op_sel_hi:[0,1,1]
    v_pk_fma_f32 v[154:155], v[72:73], v[58:59], v[154:155] op_sel:[0,0,0] op_sel_hi:[0,1,1]
    v_pk_fma_f32 v[156:157], v[76:77], v[60:61], v[156:157] op_sel:[0,0,0] op_sel_hi:[0,1,1]
    v_pk_fma_f32 v[158:159], v[76:77], v[62:63], v[158:159] op_sel:[0,0,0] op_sel_hi:[0,1,1]
    s_set_gpr_idx_idx s45
    v_pk_fma_f32 v[152:153], v[72:73], v[64:65], v[152:153] op_sel:[1,0,0] op_sel_hi:[1,1,1]
    v_pk_fma_f32 v[154:155], v[72:73], v[66:67], v[154:155] op_sel:[1,0,0] op_sel_hi:[1,1,1]
    v_pk_fma_f32 v[156:157], v[76:77], v[68:69], v[156:157] op_sel:[1,0,0] op_sel_hi:[1,1,1]
    v_pk_fma_f32 v[158:159], v[76:77], v[70:71], v[158:159] op_sel:[1,0,0] op_sel_hi:[1,1,1]
    s_set_gpr_idx_off
    v_pk_mul_f32 v[80:81], v[120:121], v[28:29]
    v_pk_mul_f32 v[82:83], v[122:123], v[30:31]
    s_waitcnt vmcnt(4)
    buffer_load_dwordx4 v[88:91], v1, s[20:23], s38 offen
    buffer_load_dwordx4 v[92:95], v1, s[20:23], s39 offen
    v_mfma_f32_4x4x4_16b_bf16 v[56:59], v[22:23], v[96:97], 0 cbsz:4 abid:2
    v_exp_f32 v28, v136
    v_mfma_f32_4x4x4_16b_bf16 v[60:63], v[22:23], v[98:99], 0 cbsz:4 abid:2
    v_exp_f32 v29, v137
    v_mfma_f32_4x4x4_16b_bf16 v[64:67], v[22:23], v[100:101], 0 cbsz:4 abid:3
    v_exp_f32 v30, v138
    v_mfma_f32_4x4x4_16b_bf16 v[68:71], v[22:23], v[102:103], 0 cbsz:4 abid:3
    v_exp_f32 v31, v139
    v_readlane_b32 s54, v11, 4
    v_readlane_b32 s55, v11, 5
    v_pk_add_f32 v[28:29], v[28:29], 1.0 op_sel_hi:[1,0]
    v_pk_add_f32 v[30:31], v[30:31], 1.0 op_sel_hi:[1,0]
    v_rcp_f32 v28, v28
    v_rcp_f32 v29, v29
    v_rcp_f32 v30, v30
    v_rcp_f32 v31, v31
    s_waitcnt lgkmcnt(0)
    ds_read_b64 v[20:21], v13
    ds_read2_b64 v[16:19], v12 offset0:1 offset1:1
    s_and_b32 s38, s54, 0xfffffc00
    s_and_b32 s39, s55, 0xfffffc00
    s_set_gpr_idx_on s46, 0xc
    v_pk_fma_f32 v[152:153], v[74:75], v[56:57], v[152:153] op_sel:[0,0,0] op_sel_hi:[0,1,1]
    v_pk_fma_f32 v[154:155], v[74:75], v[58:59], v[154:155] op_sel:[0,0,0] op_sel_hi:[0,1,1]
    v_pk_fma_f32 v[156:157], v[78:79], v[60:61], v[156:157] op_sel:[0,0,0] op_sel_hi:[0,1,1]
    v_pk_fma_f32 v[158:159], v[78:79], v[62:63], v[158:159] op_sel:[0,0,0] op_sel_hi:[0,1,1]
    s_set_gpr_idx_idx s47
    v_pk_fma_f32 v[152:153], v[74:75], v[64:65], v[152:153] op_sel:[1,0,0] op_sel_hi:[1,1,1]
    v_pk_fma_f32 v[154:155], v[74:75], v[66:67], v[154:155] op_sel:[1,0,0] op_sel_hi:[1,1,1]
    v_pk_fma_f32 v[156:157], v[78:79], v[68:69], v[156:157] op_sel:[1,0,0] op_sel_hi:[1,1,1]
    v_pk_fma_f32 v[158:159], v[78:79], v[70:71], v[158:159] op_sel:[1,0,0] op_sel_hi:[1,1,1]
    s_set_gpr_idx_off
    v_pk_mul_f32 v[84:85], v[136:137], v[28:29]
    v_pk_mul_f32 v[86:87], v[138:139], v[30:31]
    v_add_u32 v8, v10, v8
    v_add_u32 v9, 128, v9
    s_waitcnt vmcnt(4)
    buffer_load_dwordx4 v[96:99], v1, s[20:23], s38 offen
    buffer_load_dwordx4 v[100:103], v1, s[20:23], s39 offen
    v_mfma_f32_4x4x4_16b_bf16 v[56:59], v[22:23], v[104:105], 0 cbsz:4 abid:4
    v_exp_f32 v28, v124
    v_mfma_f32_4x4x4_16b_bf16 v[60:63], v[22:23], v[106:107], 0 cbsz:4 abid:4
    v_exp_f32 v29, v125
    v_mfma_f32_4x4x4_16b_bf16 v[64:67], v[22:23], v[108:109], 0 cbsz:4 abid:5
    v_exp_f32 v30, v126
    v_mfma_f32_4x4x4_16b_bf16 v[68:71], v[22:23], v[110:111], 0 cbsz:4 abid:5
    v_exp_f32 v31, v127
    v_readlane_b32 s56, v11, 6
    v_readlane_b32 s57, v11, 7
    v_pk_add_f32 v[28:29], v[28:29], 1.0 op_sel_hi:[1,0]
    v_pk_add_f32 v[30:31], v[30:31], 1.0 op_sel_hi:[1,0]
    v_rcp_f32 v28, v28
    v_rcp_f32 v29, v29
    v_rcp_f32 v30, v30
    v_rcp_f32 v31, v31
    s_and_b32 s38, s56, 0xfffffc00
    s_and_b32 s39, s57, 0xfffffc00
    s_set_gpr_idx_on s48, 0xc
    v_pk_fma_f32 v[152:153], v[80:81], v[56:57], v[152:153] op_sel:[0,0,0] op_sel_hi:[0,1,1]
    v_pk_fma_f32 v[154:155], v[80:81], v[58:59], v[154:155] op_sel:[0,0,0] op_sel_hi:[0,1,1]
    v_pk_fma_f32 v[156:157], v[84:85], v[60:61], v[156:157] op_sel:[0,0,0] op_sel_hi:[0,1,1]
    v_pk_fma_f32 v[158:159], v[84:85], v[62:63], v[158:159] op_sel:[0,0,0] op_sel_hi:[0,1,1]
    s_set_gpr_idx_idx s49
    v_pk_fma_f32 v[152:153], v[80:81], v[64:65], v[152:153] op_sel:[1,0,0] op_sel_hi:[1,1,1]
    v_pk_fma_f32 v[154:155], v[80:81], v[66:67], v[154:155] op_sel:[1,0,0] op_sel_hi:[1,1,1]
    v_pk_fma_f32 v[156:157], v[84:85], v[68:69], v[156:157] op_sel:[1,0,0] op_sel_hi:[1,1,1]
    v_pk_fma_f32 v[158:159], v[84:85], v[70:71], v[158:159] op_sel:[1,0,0] op_sel_hi:[1,1,1]
    s_set_gpr_idx_off
    v_pk_mul_f32 v[72:73], v[124:125], v[28:29]
    v_pk_mul_f32 v[74:75], v[126:127], v[30:31]
    s_waitcnt lgkmcnt(0)
    v_dot2_f32_bf16 v24, v20, v48, 0
    v_dot2_f32_bf16 v25, v20, v50, 0
    s_waitcnt vmcnt(4)
    buffer_load_dwordx4 v[104:107], v1, s[20:23], s38 offen
    buffer_load_dwordx4 v[108:111], v1, s[20:23], s39 offen
    v_mfma_f32_4x4x4_16b_bf16 v[56:59], v[22:23], v[112:113], 0 cbsz:4 abid:6
    v_exp_f32 v28, v140
    v_mfma_f32_4x4x4_16b_bf16 v[60:63], v[22:23], v[114:115], 0 cbsz:4 abid:6
    v_exp_f32 v29, v141
    v_mfma_f32_4x4x4_16b_bf16 v[64:67], v[22:23], v[116:117], 0 cbsz:4 abid:7
    v_exp_f32 v30, v142
    v_mfma_f32_4x4x4_16b_bf16 v[68:71], v[22:23], v[118:119], 0 cbsz:4 abid:7
    v_exp_f32 v31, v143
    v_readlane_b32 s58, v11, 8
    v_readlane_b32 s59, v11, 9
    v_pk_add_f32 v[28:29], v[28:29], 1.0 op_sel_hi:[1,0]
    v_pk_add_f32 v[30:31], v[30:31], 1.0 op_sel_hi:[1,0]
    v_rcp_f32 v28, v28
    v_rcp_f32 v29, v29
    v_rcp_f32 v30, v30
    v_rcp_f32 v31, v31
    s_and_b32 s38, s58, 0xfffffc00
    s_and_b32 s39, s59, 0xfffffc00
    s_set_gpr_idx_on s50, 0xc
    v_pk_fma_f32 v[152:153], v[82:83], v[56:57], v[152:153] op_sel:[0,0,0] op_sel_hi:[0,1,1]
    v_pk_fma_f32 v[154:155], v[82:83], v[58:59], v[154:155] op_sel:[0,0,0] op_sel_hi:[0,1,1]
    v_pk_fma_f32 v[156:157], v[86:87], v[60:61], v[156:157] op_sel:[0,0,0] op_sel_hi:[0,1,1]
    v_pk_fma_f32 v[158:159], v[86:87], v[62:63], v[158:159] op_sel:[0,0,0] op_sel_hi:[0,1,1]
    s_set_gpr_idx_idx s51
    v_pk_fma_f32 v[152:153], v[82:83], v[64:65], v[152:153] op_sel:[1,0,0] op_sel_hi:[1,1,1]
    v_pk_fma_f32 v[154:155], v[82:83], v[66:67], v[154:155] op_sel:[1,0,0] op_sel_hi:[1,1,1]
    v_pk_fma_f32 v[156:157], v[86:87], v[68:69], v[156:157] op_sel:[1,0,0] op_sel_hi:[1,1,1]
    v_pk_fma_f32 v[158:159], v[86:87], v[70:71], v[158:159] op_sel:[1,0,0] op_sel_hi:[1,1,1]
    s_set_gpr_idx_off
    v_pk_mul_f32 v[76:77], v[140:141], v[28:29]
    v_pk_mul_f32 v[78:79], v[142:143], v[30:31]
    v_dot2_f32_bf16 v26, v20, v52, 0
    v_dot2_f32_bf16 v27, v20, v54, 0
    s_waitcnt vmcnt(4)
    buffer_load_dwordx4 v[112:115], v1, s[20:23], s38 offen
    buffer_load_dwordx4 v[116:119], v1, s[20:23], s39 offen
    v_mfma_f32_4x4x4_16b_bf16 v[56:59], v[22:23], v[88:89], 0 cbsz:4 abid:8
    v_exp_f32 v28, v128
    v_mfma_f32_4x4x4_16b_bf16 v[60:63], v[22:23], v[90:91], 0 cbsz:4 abid:8
    v_exp_f32 v29, v129
    v_mfma_f32_4x4x4_16b_bf16 v[64:67], v[22:23], v[92:93], 0 cbsz:4 abid:9
    v_exp_f32 v30, v130
    v_mfma_f32_4x4x4_16b_bf16 v[68:71], v[22:23], v[94:95], 0 cbsz:4 abid:9
    v_exp_f32 v31, v131
    v_readlane_b32 s44, v11, 10
    v_readlane_b32 s45, v11, 11
    v_pk_add_f32 v[28:29], v[28:29], 1.0 op_sel_hi:[1,0]
    v_pk_add_f32 v[30:31], v[30:31], 1.0 op_sel_hi:[1,0]
    v_rcp_f32 v28, v28
    v_rcp_f32 v29, v29
    v_rcp_f32 v30, v30
    v_rcp_f32 v31, v31
    s_and_b32 s38, s44, 0xfffffc00
    s_and_b32 s39, s45, 0xfffffc00
    s_set_gpr_idx_on s52, 0xc
    v_pk_fma_f32 v[152:153], v[72:73], v[56:57], v[152:153] op_sel:[0,0,0] op_sel_hi:[0,1,1]
    v_pk_fma_f32 v[154:155], v[72:73], v[58:59], v[154:155] op_sel:[0,0,0] op_sel_hi:[0,1,1]
    v_pk_fma_f32 v[156:157], v[76:77], v[60:61], v[156:157] op_sel:[0,0,0] op_sel_hi:[0,1,1]
    v_pk_fma_f32 v[158:159], v[76:77], v[62:63], v[158:159] op_sel:[0,0,0] op_sel_hi:[0,1,1]
    s_set_gpr_idx_idx s53
    v_pk_fma_f32 v[152:153], v[72:73], v[64:65], v[152:153] op_sel:[1,0,0] op_sel_hi:[1,1,1]
    v_pk_fma_f32 v[154:155], v[72:73], v[66:67], v[154:155] op_sel:[1,0,0] op_sel_hi:[1,1,1]
    v_pk_fma_f32 v[156:157], v[76:77], v[68:69], v[156:157] op_sel:[1,0,0] op_sel_hi:[1,1,1]
    v_pk_fma_f32 v[158:159], v[76:77], v[70:71], v[158:159] op_sel:[1,0,0] op_sel_hi:[1,1,1]
    s_set_gpr_idx_off
    v_pk_mul_f32 v[80:81], v[128:129], v[28:29]
    v_pk_mul_f32 v[82:83], v[130:131], v[30:31]
    v_dot2_f32_bf16 v24, v21, v49, v24
    v_dot2_f32_bf16 v25, v21, v51, v25
    s_waitcnt vmcnt(4)
    buffer_load_dwordx4 v[88:91], v1, s[20:23], s38 offen
    buffer_load_dwordx4 v[92:95], v1, s[20:23], s39 offen
    v_mfma_f32_4x4x4_16b_bf16 v[56:59], v[22:23], v[96:97], 0 cbsz:4 abid:10
    v_exp_f32 v28, v144
    v_mfma_f32_4x4x4_16b_bf16 v[60:63], v[22:23], v[98:99], 0 cbsz:4 abid:10
    v_exp_f32 v29, v145
    v_mfma_f32_4x4x4_16b_bf16 v[64:67], v[22:23], v[100:101], 0 cbsz:4 abid:11
    v_exp_f32 v30, v146
    v_mfma_f32_4x4x4_16b_bf16 v[68:71], v[22:23], v[102:103], 0 cbsz:4 abid:11
    v_exp_f32 v31, v147
    v_readlane_b32 s46, v11, 12
    v_readlane_b32 s47, v11, 13
    v_pk_add_f32 v[28:29], v[28:29], 1.0 op_sel_hi:[1,0]
    v_pk_add_f32 v[30:31], v[30:31], 1.0 op_sel_hi:[1,0]
    v_rcp_f32 v28, v28
    v_rcp_f32 v29, v29
    v_rcp_f32 v30, v30
    v_rcp_f32 v31, v31
    s_and_b32 s38, s46, 0xfffffc00
    s_and_b32 s39, s47, 0xfffffc00
    s_set_gpr_idx_on s54, 0xc
    v_pk_fma_f32 v[152:153], v[74:75], v[56:57], v[152:153] op_sel:[0,0,0] op_sel_hi:[0,1,1]
    v_pk_fma_f32 v[154:155], v[74:75], v[58:59], v[154:155] op_sel:[0,0,0] op_sel_hi:[0,1,1]
    v_pk_fma_f32 v[156:157], v[78:79], v[60:61], v[156:157] op_sel:[0,0,0] op_sel_hi:[0,1,1]
    v_pk_fma_f32 v[158:159], v[78:79], v[62:63], v[158:159] op_sel:[0,0,0] op_sel_hi:[0,1,1]
    s_set_gpr_idx_idx s55
    v_pk_fma_f32 v[152:153], v[74:75], v[64:65], v[152:153] op_sel:[1,0,0] op_sel_hi:[1,1,1]
    v_pk_fma_f32 v[154:155], v[74:75], v[66:67], v[154:155] op_sel:[1,0,0] op_sel_hi:[1,1,1]
    v_pk_fma_f32 v[156:157], v[78:79], v[68:69], v[156:157] op_sel:[1,0,0] op_sel_hi:[1,1,1]
    v_pk_fma_f32 v[158:159], v[78:79], v[70:71], v[158:159] op_sel:[1,0,0] op_sel_hi:[1,1,1]
    s_set_gpr_idx_off
    v_pk_mul_f32 v[84:85], v[144:145], v[28:29]
    v_pk_mul_f32 v[86:87], v[146:147], v[30:31]
    v_dot2_f32_bf16 v26, v21, v53, v26
    v_dot2_f32_bf16 v27, v21, v55, v27
    s_waitcnt vmcnt(4)
    buffer_load_dwordx4 v[96:99], v1, s[20:23], s38 offen
    buffer_load_dwordx4 v[100:103], v1, s[20:23], s39 offen
    v_mfma_f32_4x4x4_16b_bf16 v[56:59], v[22:23], v[104:105], 0 cbsz:4 abid:12
    v_exp_f32 v28, v132
    v_mfma_f32_4x4x4_16b_bf16 v[60:63], v[22:23], v[106:107], 0 cbsz:4 abid:12
    v_exp_f32 v29, v133
    v_mfma_f32_4x4x4_16b_bf16 v[64:67], v[22:23], v[108:109], 0 cbsz:4 abid:13
    v_exp_f32 v30, v134
    v_mfma_f32_4x4x4_16b_bf16 v[68:71], v[22:23], v[110:111], 0 cbsz:4 abid:13
    v_exp_f32 v31, v135
    v_readlane_b32 s48, v11, 14
    v_readlane_b32 s49, v11, 15
    v_pk_add_f32 v[28:29], v[28:29], 1.0 op_sel_hi:[1,0]
    v_pk_add_f32 v[30:31], v[30:31], 1.0 op_sel_hi:[1,0]
    v_rcp_f32 v28, v28
    v_rcp_f32 v29, v29
    v_rcp_f32 v30, v30
    v_rcp_f32 v31, v31
    s_and_b32 s38, s48, 0xfffffc00
    s_and_b32 s39, s49, 0xfffffc00
    s_set_gpr_idx_on s56, 0xc
    v_pk_fma_f32 v[152:153], v[80:81], v[56:57], v[152:153] op_sel:[0,0,0] op_sel_hi:[0,1,1]
    v_pk_fma_f32 v[154:155], v[80:81], v[58:59], v[154:155] op_sel:[0,0,0] op_sel_hi:[0,1,1]
    v_pk_fma_f32 v[156:157], v[84:85], v[60:61], v[156:157] op_sel:[0,0,0] op_sel_hi:[0,1,1]
    v_pk_fma_f32 v[158:159], v[84:85], v[62:63], v[158:159] op_sel:[0,0,0] op_sel_hi:[0,1,1]
    s_set_gpr_idx_idx s57
    v_pk_fma_f32 v[152:153], v[80:81], v[64:65], v[152:153] op_sel:[1,0,0] op_sel_hi:[1,1,1]
    v_pk_fma_f32 v[154:155], v[80:81], v[66:67], v[154:155] op_sel:[1,0,0] op_sel_hi:[1,1,1]
    v_pk_fma_f32 v[156:157], v[84:85], v[68:69], v[156:157] op_sel:[1,0,0] op_sel_hi:[1,1,1]
    v_pk_fma_f32 v[158:159], v[84:85], v[70:71], v[158:159] op_sel:[1,0,0] op_sel_hi:[1,1,1]
    s_set_gpr_idx_off
    v_pk_mul_f32 v[72:73], v[132:133], v[28:29]
    v_pk_mul_f32 v[74:75], v[134:135], v[30:31]
    s_waitcnt vmcnt(4)
    buffer_load_dwordx4 v[104:107], v1, s[20:23], s38 offen
    buffer_load_dwordx4 v[108:111], v1, s[20:23], s39 offen
    v_mfma_f32_4x4x4_16b_bf16 v[56:59], v[22:23], v[112:113], 0 cbsz:4 abid:14
    v_exp_f32 v28, v148
    v_mfma_f32_4x4x4_16b_bf16 v[60:63], v[22:23], v[114:115], 0 cbsz:4 abid:14
    v_exp_f32 v29, v149
    v_mfma_f32_4x4x4_16b_bf16 v[64:67], v[22:23], v[116:117], 0 cbsz:4 abid:15
    v_exp_f32 v30, v150
    v_mfma_f32_4x4x4_16b_bf16 v[68:71], v[22:23], v[118:119], 0 cbsz:4 abid:15
    v_exp_f32 v31, v151
    v_readlane_b32 s50, v11, 16
    v_readlane_b32 s51, v11, 17
    v_pk_add_f32 v[28:29], v[28:29], 1.0 op_sel_hi:[1,0]
    v_pk_add_f32 v[30:31], v[30:31], 1.0 op_sel_hi:[1,0]
    v_mfma_f32_32x32x16_bf16 v[120:135], v[16:19], v[40:43], 0
    v_rcp_f32 v28, v28
    v_rcp_f32 v29, v29
    v_rcp_f32 v30, v30
    v_rcp_f32 v31, v31
    ds_read_b32 v11, v7 offset:48
    s_and_b32 s38, s50, 0xfffffc00
    s_and_b32 s39, s51, 0xfffffc00
    s_set_gpr_idx_on s58, 0xc
    v_pk_fma_f32 v[152:153], v[82:83], v[56:57], v[152:153] op_sel:[0,0,0] op_sel_hi:[0,1,1]
    v_pk_fma_f32 v[154:155], v[82:83], v[58:59], v[154:155] op_sel:[0,0,0] op_sel_hi:[0,1,1]
    v_pk_fma_f32 v[156:157], v[86:87], v[60:61], v[156:157] op_sel:[0,0,0] op_sel_hi:[0,1,1]
    v_pk_fma_f32 v[158:159], v[86:87], v[62:63], v[158:159] op_sel:[0,0,0] op_sel_hi:[0,1,1]
    s_set_gpr_idx_idx s59
    v_pk_fma_f32 v[152:153], v[82:83], v[64:65], v[152:153] op_sel:[1,0,0] op_sel_hi:[1,1,1]
    v_pk_fma_f32 v[154:155], v[82:83], v[66:67], v[154:155] op_sel:[1,0,0] op_sel_hi:[1,1,1]
    v_pk_fma_f32 v[156:157], v[86:87], v[68:69], v[156:157] op_sel:[1,0,0] op_sel_hi:[1,1,1]
    v_pk_fma_f32 v[158:159], v[86:87], v[70:71], v[158:159] op_sel:[1,0,0] op_sel_hi:[1,1,1]
    s_set_gpr_idx_off
    v_pk_mul_f32 v[76:77], v[148:149], v[28:29]
    v_pk_mul_f32 v[78:79], v[150:151], v[30:31]
    v_cvt_pk_bf16_f32 v22, v24, v25
    v_cvt_pk_bf16_f32 v23, v26, v27
    v_add_u32 v7, 128, v7
    s_sub_u32 s37, s37, 8
    s_cmp_ge_u32 s37, 8
    s_cbranch_scc1 Lm_loop
Lm_tail:
    s_cmp_eq_u32 s37, 0
    s_cbranch_scc1 Lm_done
    s_waitcnt vmcnt(4)
    buffer_load_dwordx4 v[112:115], v1, s[20:23], s38 offen
    buffer_load_dwordx4 v[116:119], v1, s[20:23], s39 offen
    v_mfma_f32_4x4x4_16b_bf16 v[56:59], v[22:23], v[88:89], 0 cbsz:4 abid:0
    v_exp_f32 v28, v120
    v_mfma_f32_4x4x4_16b_bf16 v[60:63], v[22:23], v[90:91], 0 cbsz:4 abid:0
    v_exp_f32 v29, v121
    v_mfma_f32_4x4x4_16b_bf16 v[64:67], v[22:23], v[92:93], 0 cbsz:4 abid:1
    v_exp_f32 v30, v122
    v_mfma_f32_4x4x4_16b_bf16 v[68:71], v[22:23], v[94:95], 0 cbsz:4 abid:1
    v_exp_f32 v31, v123
    s_waitcnt lgkmcnt(0)
    v_readlane_b32 s52, v11, 2
    v_readlane_b32 s53, v11, 3
    v_pk_add_f32 v[28:29], v[28:29], 1.0 op_sel_hi:[1,0]
    v_pk_add_f32 v[30:31], v[30:31], 1.0 op_sel_hi:[1,0]
    v_mfma_f32_32x32x16_bf16 v[136:151], v[16:19], v[44:47], 0
    v_rcp_f32 v28, v28
    v_rcp_f32 v29, v29
    v_rcp_f32 v30, v30
    v_rcp_f32 v31, v31
    s_and_b32 s38, s52, 0xfffffc00
    s_and_b32 s39, s53, 0xfffffc00
    s_set_gpr_idx_on s44, 0xc
    v_pk_fma_f32 v[152:153], v[72:73], v[56:57], v[152:153] op_sel:[0,0,0] op_sel_hi:[0,1,1]
    v_pk_fma_f32 v[154:155], v[72:73], v[58:59], v[154:155] op_sel:[0,0,0] op_sel_hi:[0,1,1]
    v_pk_fma_f32 v[156:157], v[76:77], v[60:61], v[156:157] op_sel:[0,0,0] op_sel_hi:[0,1,1]
    v_pk_fma_f32 v[158:159], v[76:77], v[62:63], v[158:159] op_sel:[0,0,0] op_sel_hi:[0,1,1]
    s_set_gpr_idx_idx s45
    v_pk_fma_f32 v[152:153], v[72:73], v[64:65], v[152:153] op_sel:[1,0,0] op_sel_hi:[1,1,1]
    v_pk_fma_f32 v[154:155], v[72:73], v[66:67], v[154:155] op_sel:[1,0,0] op_sel_hi:[1,1,1]
    v_pk_fma_f32 v[156:157], v[76:77], v[68:69], v[156:157] op_sel:[1,0,0] op_sel_hi:[1,1,1]
    v_pk_fma_f32 v[158:159], v[76:77], v[70:71], v[158:159] op_sel:[1,0,0] op_sel_hi:[1,1,1]
    s_set_gpr_idx_off
    v_pk_mul_f32 v[80:81], v[120:121], v[28:29]
    v_pk_mul_f32 v[82:83], v[122:123], v[30:31]
    s_cmp_eq_u32 s37, 1
    s_cbranch_scc1 Lm_done
    s_waitcnt vmcnt(4)
    buffer_load_dwordx4 v[88:91], v1, s[20:23], s38 offen
    buffer_load_dwordx4 v[92:95], v1, s[20:23], s39 offen
    v_mfma_f32_4x4x4_16b_bf16 v[56:59], v[22:23], v[96:97], 0 cbsz:4 abid:2
    v_exp_f32 v28, v136
    v_mfma_f32_4x4x4_16b_bf16 v[60:63], v[22:23], v[98:99], 0 cbsz:4 abid:2
    v_exp_f32 v29, v137
    v_mfma_f32_4x4x4_16b_bf16 v[64:67], v[22:23], v[100:101], 0 cbsz:4 abid:3
    v_exp_f32 v30, v138
    v_mfma_f32_4x4x4_16b_bf16 v[68:71], v[22:23], v[102:103], 0 cbsz:4 abid:3
    v_exp_f32 v31, v139
    v_readlane_b32 s54, v11, 4
    v_readlane_b32 s55, v11, 5
    v_pk_add_f32 v[28:29], v[28:29], 1.0 op_sel_hi:[1,0]
    v_pk_add_f32 v[30:31], v[30:31], 1.0 op_sel_hi:[1,0]
    v_rcp_f32 v28, v28
    v_rcp_f32 v29, v29
    v_rcp_f32 v30, v30
    v_rcp_f32 v31, v31
    s_and_b32 s38, s54, 0xfffffc00
    s_and_b32 s39, s55, 0xfffffc00
    s_set_gpr_idx_on s46, 0xc
    v_pk_fma_f32 v[152:153], v[74:75], v[56:57], v[152:153] op_sel:[0,0,0] op_sel_hi:[0,1,1]
    v_pk_fma_f32 v[154:155], v[74:75], v[58:59], v[154:155] op_sel:[0,0,0] op_sel_hi:[0,1,1]
    v_pk_fma_f32 v[156:157], v[78:79], v[60:61], v[156:157] op_sel:[0,0,0] op_sel_hi:[0,1,1]
    v_pk_fma_f32 v[158:159], v[78:79], v[62:63], v[158:159] op_sel:[0,0,0] op_sel_hi:[0,1,1]
    s_set_gpr_idx_idx s47
    v_pk_fma_f32 v[152:153], v[74:75], v[64:65], v[152:153] op_sel:[1,0,0] op_sel_hi:[1,1,1]
    v_pk_fma_f32 v[154:155], v[74:75], v[66:67], v[154:155] op_sel:[1,0,0] op_sel_hi:[1,1,1]
    v_pk_fma_f32 v[156:157], v[78:79], v[68:69], v[156:157] op_sel:[1,0,0] op_sel_hi:[1,1,1]
    v_pk_fma_f32 v[158:159], v[78:79], v[70:71], v[158:159] op_sel:[1,0,0] op_sel_hi:[1,1,1]
    s_set_gpr_idx_off
    v_pk_mul_f32 v[84:85], v[136:137], v[28:29]
    v_pk_mul_f32 v[86:87], v[138:139], v[30:31]
    s_cmp_eq_u32 s37, 2
    s_cbranch_scc1 Lm_done
    s_waitcnt vmcnt(4)
    buffer_load_dwordx4 v[96:99], v1, s[20:23], s38 offen
    buffer_load_dwordx4 v[100:103], v1, s[20:23], s39 offen
    v_mfma_f32_4x4x4_16b_bf16 v[56:59], v[22:23], v[104:105], 0 cbsz:4 abid:4
    v_exp_f32 v28, v124
    v_mfma_f32_4x4x4_16b_bf16 v[60:63], v[22:23], v[106:107], 0 cbsz:4 abid:4
    v_exp_f32 v29, v125
    v_mfma_f32_4x4x4_16b_bf16 v[64:67], v[22:23], v[108:109], 0 cbsz:4 abid:5
    v_exp_f32 v30, v126
    v_mfma_f32_4x4x4_16b_bf16 v[68:71], v[22:23], v[110:111], 0 cbsz:4 abid:5
    v_exp_f32 v31, v127
    v_readlane_b32 s56, v11, 6
    v_readlane_b32 s57, v11, 7
    v_pk_add_f32 v[28:29], v[28:29], 1.0 op_sel_hi:[1,0]
    v_pk_add_f32 v[30:31], v[30:31], 1.0 op_sel_hi:[1,0]
    v_rcp_f32 v28, v28
    v_rcp_f32 v29, v29
    v_rcp_f32 v30, v30
    v_rcp_f32 v31, v31
    s_and_b32 s38, s56, 0xfffffc00
    s_and_b32 s39, s57, 0xfffffc00
    s_set_gpr_idx_on s48, 0xc
    v_pk_fma_f32 v[152:153], v[80:81], v[56:57], v[152:153] op_sel:[0,0,0] op_sel_hi:[0,1,1]
    v_pk_fma_f32 v[154:155], v[80:81], v[58:59], v[154:155] op_sel:[0,0,0] op_sel_hi:[0,1,1]
    v_pk_fma_f32 v[156:157], v[84:85], v[60:61], v[156:157] op_sel:[0,0,0] op_sel_hi:[0,1,1]
    v_pk_fma_f32 v[158:159], v[84:85], v[62:63], v[158:159] op_sel:[0,0,0] op_sel_hi:[0,1,1]
    s_set_gpr_idx_idx s49
    v_pk_fma_f32 v[152:153], v[80:81], v[64:65], v[152:153] op_sel:[1,0,0] op_sel_hi:[1,1,1]
    v_pk_fma_f32 v[154:155], v[80:81], v[66:67], v[154:155] op_sel:[1,0,0] op_sel_hi:[1,1,1]
    v_pk_fma_f32 v[156:157], v[84:85], v[68:69], v[156:157] op_sel:[1,0,0] op_sel_hi:[1,1,1]
    v_pk_fma_f32 v[158:159], v[84:85], v[70:71], v[158:159] op_sel:[1,0,0] op_sel_hi:[1,1,1]
    s_set_gpr_idx_off
    v_pk_mul_f32 v[72:73], v[124:125], v[28:29]
    v_pk_mul_f32 v[74:75], v[126:127], v[30:31]
    s_cmp_eq_u32 s37, 3
    s_cbranch_scc1 Lm_done
    s_waitcnt vmcnt(4)
    buffer_load_dwordx4 v[104:107], v1, s[20:23], s38 offen
    buffer_load_dwordx4 v[108:111], v1, s[20:23], s39 offen
    v_mfma_f32_4x4x4_16b_bf16 v[56:59], v[22:23], v[112:113], 0 cbsz:4 abid:6
    v_exp_f32 v28, v140
    v_mfma_f32_4x4x4_16b_bf16 v[60:63], v[22:23], v[114:115], 0 cbsz:4 abid:6
    v_exp_f32 v29, v141
    v_mfma_f32_4x4x4_16b_bf16 v[64:67], v[22:23], v[116:117], 0 cbsz:4 abid:7
    v_exp_f32 v30, v142
    v_mfma_f32_4x4x4_16b_bf16 v[68:71], v[22:23], v[118:119], 0 cbsz:4 abid:7
    v_exp_f32 v31, v143
    s_nop 0
    v_pk_add_f32 v[28:29], v[28:29], 1.0 op_sel_hi:[1,0]
    v_pk_add_f32 v[30:31], v[30:31], 1.0 op_sel_hi:[1,0]
    v_rcp_f32 v28, v28
    v_rcp_f32 v29, v29
    v_rcp_f32 v30, v30
    v_rcp_f32 v31, v31
    s_set_gpr_idx_on s50, 0xc
    v_pk_fma_f32 v[152:153], v[82:83], v[56:57], v[152:153] op_sel:[0,0,0] op_sel_hi:[0,1,1]
    v_pk_fma_f32 v[154:155], v[82:83], v[58:59], v[154:155] op_sel:[0,0,0] op_sel_hi:[0,1,1]
    v_pk_fma_f32 v[156:157], v[86:87], v[60:61], v[156:157] op_sel:[0,0,0] op_sel_hi:[0,1,1]
    v_pk_fma_f32 v[158:159], v[86:87], v[62:63], v[158:159] op_sel:[0,0,0] op_sel_hi:[0,1,1]
    s_set_gpr_idx_idx s51
    v_pk_fma_f32 v[152:153], v[82:83], v[64:65], v[152:153] op_sel:[1,0,0] op_sel_hi:[1,1,1]
    v_pk_fma_f32 v[154:155], v[82:83], v[66:67], v[154:155] op_sel:[1,0,0] op_sel_hi:[1,1,1]
    v_pk_fma_f32 v[156:157], v[86:87], v[68:69], v[156:157] op_sel:[1,0,0] op_sel_hi:[1,1,1]
    v_pk_fma_f32 v[158:159], v[86:87], v[70:71], v[158:159] op_sel:[1,0,0] op_sel_hi:[1,1,1]
    s_set_gpr_idx_off
    v_pk_mul_f32 v[76:77], v[140:141], v[28:29]
    v_pk_mul_f32 v[78:79], v[142:143], v[30:31]
    s_cmp_eq_u32 s37, 4
    s_cbranch_scc1 Lm_done
    s_waitcnt vmcnt(4)
    v_mfma_f32_4x4x4_16b_bf16 v[56:59], v[22:23], v[88:89], 0 cbsz:4 abid:8
    v_exp_f32 v28, v128
    v_mfma_f32_4x4x4_16b_bf16 v[60:63], v[22:23], v[90:91], 0 cbsz:4 abid:8
    v_exp_f32 v29, v129
    v_mfma_f32_4x4x4_16b_bf16 v[64:67], v[22:23], v[92:93], 0 cbsz:4 abid:9
    v_exp_f32 v30, v130
    v_mfma_f32_4x4x4_16b_bf16 v[68:71], v[22:23], v[94:95], 0 cbsz:4 abid:9
    v_exp_f32 v31, v131
    s_nop 0
    v_pk_add_f32 v[28:29], v[28:29], 1.0 op_sel_hi:[1,0]
    v_pk_add_f32 v[30:31], v[30:31], 1.0 op_sel_hi:[1,0]
    v_rcp_f32 v28, v28
    v_rcp_f32 v29, v29
    v_rcp_f32 v30, v30
    v_rcp_f32 v31, v31
    s_set_gpr_idx_on s52, 0xc
    v_pk_fma_f32 v[152:153], v[72:73], v[56:57], v[152:153] op_sel:[0,0,0] op_sel_hi:[0,1,1]
    v_pk_fma_f32 v[154:155], v[72:73], v[58:59], v[154:155] op_sel:[0,0,0] op_sel_hi:[0,1,1]
    v_pk_fma_f32 v[156:157], v[76:77], v[60:61], v[156:157] op_sel:[0,0,0] op_sel_hi:[0,1,1]
    v_pk_fma_f32 v[158:159], v[76:77], v[62:63], v[158:159] op_sel:[0,0,0] op_sel_hi:[0,1,1]
    s_set_gpr_idx_idx s53
    v_pk_fma_f32 v[152:153], v[72:73], v[64:65], v[152:153] op_sel:[1,0,0] op_sel_hi:[1,1,1]
    v_pk_fma_f32 v[154:155], v[72:73], v[66:67], v[154:155] op_sel:[1,0,0] op_sel_hi:[1,1,1]
    v_pk_fma_f32 v[156:157], v[76:77], v[68:69], v[156:157] op_sel:[1,0,0] op_sel_hi:[1,1,1]
    v_pk_fma_f32 v[158:159], v[76:77], v[70:71], v[158:159] op_sel:[1,0,0] op_sel_hi:[1,1,1]
    s_set_gpr_idx_off
    v_pk_mul_f32 v[80:81], v[128:129], v[28:29]
    v_pk_mul_f32 v[82:83], v[130:131], v[30:31]
    s_cmp_eq_u32 s37, 5
    s_cbranch_scc1 Lm_done
    s_waitcnt vmcnt(2)
    v_mfma_f32_4x4x4_16b_bf16 v[56:59], v[22:23], v[96:97], 0 cbsz:4 abid:10
    v_exp_f32 v28, v144
    v_mfma_f32_4x4x4_16b_bf16 v[60:63], v[22:23], v[98:99], 0 cbsz:4 abid:10
    v_exp_f32 v29, v145
    v_mfma_f32_4x4x4_16b_bf16 v[64:67], v[22:23], v[100:101], 0 cbsz:4 abid:11
    v_exp_f32 v30, v146
    v_mfma_f32_4x4x4_16b_bf16 v[68:71], v[22:23], v[102:103], 0 cbsz:4 abid:11
    v_exp_f32 v31, v147
    s_nop 0
    v_pk_add_f32 v[28:29], v[28:29], 1.0 op_sel_hi:[1,0]
    v_pk_add_f32 v[30:31], v[30:31], 1.0 op_sel_hi:[1,0]
    v_rcp_f32 v28, v28
    v_rcp_f32 v29, v29
    v_rcp_f32 v30, v30
    v_rcp_f32 v31, v31
    s_set_gpr_idx_on s54, 0xc
    v_pk_fma_f32 v[152:153], v[74:75], v[56:57], v[152:153] op_sel:[0,0,0] op_sel_hi:[0,1,1]
    v_pk_fma_f32 v[154:155], v[74:75], v[58:59], v[154:155] op_sel:[0,0,0] op_sel_hi:[0,1,1]
    v_pk_fma_f32 v[156:157], v[78:79], v[60:61], v[156:157] op_sel:[0,0,0] op_sel_hi:[0,1,1]
    v_pk_fma_f32 v[158:159], v[78:79], v[62:63], v[158:159] op_sel:[0,0,0] op_sel_hi:[0,1,1]
    s_set_gpr_idx_idx s55
    v_pk_fma_f32 v[152:153], v[74:75], v[64:65], v[152:153] op_sel:[1,0,0] op_sel_hi:[1,1,1]
    v_pk_fma_f32 v[154:155], v[74:75], v[66:67], v[154:155] op_sel:[1,0,0] op_sel_hi:[1,1,1]
    v_pk_fma_f32 v[156:157], v[78:79], v[68:69], v[156:157] op_sel:[1,0,0] op_sel_hi:[1,1,1]
    v_pk_fma_f32 v[158:159], v[78:79], v[70:71], v[158:159] op_sel:[1,0,0] op_sel_hi:[1,1,1]
    s_set_gpr_idx_off
    v_pk_mul_f32 v[84:85], v[144:145], v[28:29]
    v_pk_mul_f32 v[86:87], v[146:147], v[30:31]
    s_cmp_eq_u32 s37, 6
    s_cbranch_scc1 Lm_done
    s_waitcnt vmcnt(0)
    v_mfma_f32_4x4x4_16b_bf16 v[56:59], v[22:23], v[104:105], 0 cbsz:4 abid:12
    v_mfma_f32_4x4x4_16b_bf16 v[60:63], v[22:23], v[106:107], 0 cbsz:4 abid:12
    v_mfma_f32_4x4x4_16b_bf16 v[64:67], v[22:23], v[108:109], 0 cbsz:4 abid:13
    v_mfma_f32_4x4x4_16b_bf16 v[68:71], v[22:23], v[110:111], 0 cbsz:4 abid:13
    s_nop 3
    s_set_gpr_idx_on s56, 0xc
    v_pk_fma_f32 v[152:153], v[80:81], v[56:57], v[152:153] op_sel:[0,0,0] op_sel_hi:[0,1,1]
    v_pk_fma_f32 v[154:155], v[80:81], v[58:59], v[154:155] op_sel:[0,0,0] op_sel_hi:[0,1,1]
    v_pk_fma_f32 v[156:157], v[84:85], v[60:61], v[156:157] op_sel:[0,0,0] op_sel_hi:[0,1,1]
    v_pk_fma_f32 v[158:159], v[84:85], v[62:63], v[158:159] op_sel:[0,0,0] op_sel_hi:[0,1,1]
    s_set_gpr_idx_idx s57
    v_pk_fma_f32 v[152:153], v[80:81], v[64:65], v[152:153] op_sel:[1,0,0] op_sel_hi:[1,1,1]
    v_pk_fma_f32 v[154:155], v[80:81], v[66:67], v[154:155] op_sel:[1,0,0] op_sel_hi:[1,1,1]
    v_pk_fma_f32 v[156:157], v[84:85], v[68:69], v[156:157] op_sel:[1,0,0] op_sel_hi:[1,1,1]
    v_pk_fma_f32 v[158:159], v[84:85], v[70:71], v[158:159] op_sel:[1,0,0] op_sel_hi:[1,1,1]
    s_set_gpr_idx_off
Lm_done:
    s_cmp_lt_u32 s34, s35
    s_cbranch_scc1 Lm_next
    s_cmp_gt_u32 s42, 960
    s_cbranch_scc1 Lm_big
Lm_small:
    s_setprio 0
    s_waitcnt lgkmcnt(0)
    s_mul_i32 s40, s33, 4294963840
    v_add_u32 v32, s40, v205
    v_pk_mul_f32 v[152:153], v[152:153], s[86:87] op_sel_hi:[1,0]
    v_pk_mul_f32 v[154:155], v[154:155], s[86:87] op_sel_hi:[1,0]
    v_pk_mul_f32 v[156:157], v[156:157], s[86:87] op_sel_hi:[1,0]
    v_pk_mul_f32 v[158:159], v[158:159], s[86:87] op_sel_hi:[1,0]
    v_cvt_pk_bf16_f32 v152, v152, v156
    v_cvt_pk_bf16_f32 v153, v153, v157
    v_cvt_pk_bf16_f32 v154, v154, v158
    v_cvt_pk_bf16_f32 v155, v155, v159
    ds_write_b32 v32, v152 offset:36864
    ds_write_b32 v32, v153 offset:37152
    ds_write_b32 v32, v154 offset:37440
    ds_write_b32 v32, v155 offset:37728
    v_pk_mul_f32 v[160:161], v[160:161], s[86:87] op_sel_hi:[1,0]
    v_pk_mul_f32 v[162:163], v[162:163], s[86:87] op_sel_hi:[1,0]
    v_pk_mul_f32 v[164:165], v[164:165], s[86:87] op_sel_hi:[1,0]
    v_pk_mul_f32 v[166:167], v[166:167], s[86:87] op_sel_hi:[1,0]
    v_cvt_pk_bf16_f32 v160, v160, v164
    v_cvt_pk_bf16_f32 v161, v161, v165
    v_cvt_pk_bf16_f32 v162, v162, v166
    v_cvt_pk_bf16_f32 v163, v163, v167
    ds_write_b32 v205, v160 offset:0
    ds_write_b32 v205, v161 offset:288
    ds_write_b32 v205, v162 offset:576
    ds_write_b32 v205, v163 offset:864
    v_pk_mul_f32 v[168:169], v[168:169], s[86:87] op_sel_hi:[1,0]
    v_pk_mul_f32 v[170:171], v[170:171], s[86:87] op_sel_hi:[1,0]
    v_pk_mul_f32 v[172:173], v[172:173], s[86:87] op_sel_hi:[1,0]
    v_pk_mul_f32 v[174:175], v[174:175], s[86:87] op_sel_hi:[1,0]
    v_cvt_pk_bf16_f32 v168, v168, v172
    v_cvt_pk_bf16_f32 v169, v169, v173
    v_cvt_pk_bf16_f32 v170, v170, v174
    v_cvt_pk_bf16_f32 v171, v171, v175
    ds_write_b32 v205, v168 offset:1152
    ds_write_b32 v205, v169 offset:1440
    ds_write_b32 v205, v170 offset:1728
    ds_write_b32 v205, v171 offset:2016
    s_waitcnt lgkmcnt(4)
    v_pk_mul_f32 v[176:177], v[176:177], s[86:87] op_sel_hi:[1,0]
    v_pk_mul_f32 v[178:179], v[178:179], s[86:87] op_sel_hi:[1,0]
    v_pk_mul_f32 v[180:181], v[180:181], s[86:87] op_sel_hi:[1,0]
    v_pk_mul_f32 v[182:183], v[182:183], s[86:87] op_sel_hi:[1,0]
    v_cvt_pk_bf16_f32 v176, v176, v180
    v_cvt_pk_bf16_f32 v177, v177, v181
    v_cvt_pk_bf16_f32 v178, v178, v182
    v_cvt_pk_bf16_f32 v179, v179, v183
    ds_write_b32 v205, v176 offset:2304
    ds_write_b32 v205, v177 offset:2592
    ds_write_b32 v205, v178 offset:2880
    ds_write_b32 v205, v179 offset:3168
    v_pk_mul_f32 v[184:185], v[184:185], s[86:87] op_sel_hi:[1,0]
    v_pk_mul_f32 v[186:187], v[186:187], s[86:87] op_sel_hi:[1,0]
    v_pk_mul_f32 v[188:189], v[188:189], s[86:87] op_sel_hi:[1,0]
    v_pk_mul_f32 v[190:191], v[190:191], s[86:87] op_sel_hi:[1,0]
    v_cvt_pk_bf16_f32 v184, v184, v188
    v_cvt_pk_bf16_f32 v185, v185, v189
    v_cvt_pk_bf16_f32 v186, v186, v190
    v_cvt_pk_bf16_f32 v187, v187, v191
    ds_write_b32 v205, v184 offset:3456
    ds_write_b32 v205, v185 offset:3744
    ds_write_b32 v205, v186 offset:4032
    ds_write_b32 v205, v187 offset:4320
    v_lshl_add_u32 v196, v196, 18, v35
    v_lshl_add_u32 v197, v197, 18, v35
    s_waitcnt lgkmcnt(0)
    ds_read_b128 v[56:59], v206 offset:0
    ds_read_b128 v[60:63], v206 offset:64
    ds_read_b128 v[64:67], v206 offset:128
    ds_read_b128 v[68:71], v206 offset:192
    ds_read_b128 v[160:163], v37 offset:5632
    ds_read_b128 v[164:167], v37 offset:6656
    ds_read_b128 v[168:171], v37 offset:7680
    ds_read_b128 v[172:175], v37 offset:8704
    ds_read_b128 v[176:179], v37 offset:9728
    ds_read_b128 v[180:183], v37 offset:10752
    ds_read_b128 v[184:187], v37 offset:11776
    ds_read_b128 v[188:191], v37 offset:12800
    s_waitcnt lgkmcnt(11)
    v_mfma_f32_16x16x32_bf16 v[240:243], v[56:59], v[208:211], 0
    v_mfma_f32_16x16x32_bf16 v[244:247], v[56:59], v[212:215], 0
    s_waitcnt lgkmcnt(10)
    v_mfma_f32_16x16x32_bf16 v[240:243], v[60:63], v[216:219], v[240:243]
    v_mfma_f32_16x16x32_bf16 v[244:247], v[60:63], v[220:223], v[244:247]
    s_waitcnt lgkmcnt(9)
    v_mfma_f32_16x16x32_bf16 v[240:243], v[64:67], v[224:227], v[240:243]
    v_mfma_f32_16x16x32_bf16 v[244:247], v[64:67], v[228:231], v[244:247]
    s_waitcnt lgkmcnt(8)
    v_mfma_f32_16x16x32_bf16 v[240:243], v[68:71], v[232:235], v[240:243]
    v_mfma_f32_16x16x32_bf16 v[244:247], v[68:71], v[236:239], v[244:247]
    s_waitcnt lgkmcnt(6)
    ds_read_b128 v[208:211], v38 offset:5632
    ds_read_b128 v[212:215], v38 offset:6656
    ds_read_b128 v[216:219], v38 offset:7680
    ds_read_b128 v[220:223], v38 offset:8704
    ds_read_b128 v[224:227], v38 offset:9728
    ds_read_b128 v[228:231], v38 offset:10752
    ds_read_b128 v[232:235], v38 offset:11776
    ds_read_b128 v[236:239], v38 offset:12800
    v_mfma_f32_16x16x32_bf16 v[248:251], v[56:59], v[160:163], 0
    v_mfma_f32_16x16x32_bf16 v[252:255], v[56:59], v[164:167], 0
    s_waitcnt lgkmcnt(12)
    v_mfma_f32_16x16x32_bf16 v[248:251], v[60:63], v[168:171], v[248:251]
    v_cvt_pk_bf16_f32 v240, v240, v241
    v_cvt_pk_bf16_f32 v241, v242, v243
    v_mfma_f32_16x16x32_bf16 v[252:255], v[60:63], v[172:175], v[252:255]
    v_cvt_pk_bf16_f32 v242, v244, v245
    v_cvt_pk_bf16_f32 v243, v246, v247
    s_waitcnt lgkmcnt(10)
    v_mfma_f32_16x16x32_bf16 v[248:251], v[64:67], v[176:179], v[248:251]
    buffer_store_dwordx4 v[240:243], v196, s[24:27], s76 offen sc1
    v_mfma_f32_16x16x32_bf16 v[252:255], v[64:67], v[180:183], v[252:255]
    s_waitcnt lgkmcnt(8)
    v_mfma_f32_16x16x32_bf16 v[248:251], v[68:71], v[184:187], v[248:251]
    v_mfma_f32_16x16x32_bf16 v[252:255], v[68:71], v[188:191], v[252:255]
    s_waitcnt lgkmcnt(6)
    ds_read_b128 v[160:163], v39 offset:5632
    ds_read_b128 v[164:167], v39 offset:6656
    ds_read_b128 v[168:171], v39 offset:7680
    ds_read_b128 v[172:175], v39 offset:8704
    ds_read_b128 v[176:179], v39 offset:9728
    ds_read_b128 v[180:183], v39 offset:10752
    ds_read_b128 v[184:187], v39 offset:11776
    ds_read_b128 v[188:191], v39 offset:12800
    v_mfma_f32_16x16x32_bf16 v[240:243], v[56:59], v[208:211], 0
    v_mfma_f32_16x16x32_bf16 v[244:247], v[56:59], v[212:215], 0
    s_waitcnt lgkmcnt(12)
    v_mfma_f32_16x16x32_bf16 v[240:243], v[60:63], v[216:219], v[240:243]
    v_cvt_pk_bf16_f32 v248, v248, v249
    v_cvt_pk_bf16_f32 v249, v250, v251
    v_mfma_f32_16x16x32_bf16 v[244:247], v[60:63], v[220:223], v[244:247]
    v_cvt_pk_bf16_f32 v250, v252, v253
    v_cvt_pk_bf16_f32 v251, v254, v255
    s_waitcnt lgkmcnt(10)
    v_mfma_f32_16x16x32_bf16 v[240:243], v[64:67], v[224:227], v[240:243]
    buffer_store_dwordx4 v[248:251], v196, s[24:27], s77 offen sc1
    v_mfma_f32_16x16x32_bf16 v[244:247], v[64:67], v[228:231], v[244:247]
    s_waitcnt lgkmcnt(8)
    v_mfma_f32_16x16x32_bf16 v[240:243], v[68:71], v[232:235], v[240:243]
    v_mfma_f32_16x16x32_bf16 v[244:247], v[68:71], v[236:239], v[244:247]
    s_waitcnt lgkmcnt(6)
    s_nop 5
    v_mfma_f32_16x16x32_bf16 v[248:251], v[56:59], v[160:163], 0
    v_mfma_f32_16x16x32_bf16 v[252:255], v[56:59], v[164:167], 0
    s_waitcnt lgkmcnt(4)
    v_mfma_f32_16x16x32_bf16 v[248:251], v[60:63], v[168:171], v[248:251]
    v_cvt_pk_bf16_f32 v240, v240, v241
    v_cvt_pk_bf16_f32 v241, v242, v243
    v_mfma_f32_16x16x32_bf16 v[252:255], v[60:63], v[172:175], v[252:255]
    v_cvt_pk_bf16_f32 v242, v244, v245
    v_cvt_pk_bf16_f32 v243, v246, v247
    s_waitcnt lgkmcnt(2)
    v_mfma_f32_16x16x32_bf16 v[248:251], v[64:67], v[176:179], v[248:251]
    buffer_store_dwordx4 v[240:243], v196, s[24:27], s78 offen sc1
    v_mfma_f32_16x16x32_bf16 v[252:255], v[64:67], v[180:183], v[252:255]
    s_waitcnt lgkmcnt(0)
    v_mfma_f32_16x16x32_bf16 v[248:251], v[68:71], v[184:187], v[248:251]
    v_mfma_f32_16x16x32_bf16 v[252:255], v[68:71], v[188:191], v[252:255]
    s_nop 7
    v_cvt_pk_bf16_f32 v248, v248, v249
    v_cvt_pk_bf16_f32 v249, v250, v251
    v_cvt_pk_bf16_f32 v250, v252, v253
    v_cvt_pk_bf16_f32 v251, v254, v255
    buffer_store_dwordx4 v[248:251], v196, s[24:27], s79 offen sc1
Lm_final:
    s_setprio 0
    s_mul_i32 s40, s33, 4294963840
    v_add_u32 v205, s40, v205
    s_lshr_b32 s40, s33, 2
    s_sub_u32 s40, s40, s33
    s_mul_i32 s40, s40, 4608
    v_add_u32 v206, s40, v206
    s_waitcnt lgkmcnt(0)
    s_barrier
    ds_read_b128 v[56:59], v206 offset:36864
    ds_read_b128 v[60:63], v206 offset:36928
    ds_read_b128 v[64:67], v206 offset:36992
    ds_read_b128 v[68:71], v206 offset:37056
    s_waitcnt lgkmcnt(3)
    v_mfma_f32_16x16x32_bf16 v[240:243], v[56:59], v[160:163], 0
    v_mfma_f32_16x16x32_bf16 v[244:247], v[56:59], v[164:167], 0
    s_waitcnt lgkmcnt(2)
    v_mfma_f32_16x16x32_bf16 v[240:243], v[60:63], v[168:171], v[240:243]
    v_mfma_f32_16x16x32_bf16 v[244:247], v[60:63], v[172:175], v[244:247]
    s_waitcnt lgkmcnt(1)
    v_mfma_f32_16x16x32_bf16 v[240:243], v[64:67], v[176:179], v[240:243]
    v_mfma_f32_16x16x32_bf16 v[244:247], v[64:67], v[180:183], v[244:247]
    s_waitcnt lgkmcnt(0)
    v_mfma_f32_16x16x32_bf16 v[240:243], v[68:71], v[184:187], v[240:243]
    v_mfma_f32_16x16x32_bf16 v[244:247], v[68:71], v[188:191], v[244:247]
    s_nop 7
    v_cvt_pk_bf16_f32 v240, v240, v241
    v_cvt_pk_bf16_f32 v241, v242, v243
    v_cvt_pk_bf16_f32 v242, v244, v245
    v_cvt_pk_bf16_f32 v243, v246, v247
    buffer_store_dwordx4 v[240:243], v197, s[24:27], s79 offen sc1
    s_or_b32 s40, s2, s33
    s_cmp_lg_u32 s40, 0
    s_cbranch_scc1 Lm_noep
    v_mov_b32 v32, 565376
    v_mov_b32 v33, s41
    s_mov_b64 exec, 1
    global_store_dword v32, v33, s[28:29] sc1
Lm_noep:
Lm_end:
    s_endpgm
Lm_repoll:
    s_sub_u32 s3, s3, 1
    s_cbranch_scc1 Lm_end
    s_mov_b64 exec, vcc
    global_load_dwordx2 v[28:29], v35, s[28:29] sc1
    s_branch Lm_poll
La_other:
    s_barrier
    s_cmp_lg_u32 s33, 7
    s_cbranch_scc1 Lside_a
    v_lshlrev_b32 v32, 2, v2
    global_load_dword v56, v32, s[14:15]
    global_load_dword v57, v32, s[14:15] offset:256
    global_load_dword v58, v32, s[14:15] offset:512
    global_load_dword v59, v32, s[14:15] offset:768
Lside_a:
    s_cmp_lg_u32 s33, 6
    s_cbranch_scc1 Lside_b
    v_bfe_u32 v32, v2, 3, 2
    v_and_b32 v33, 7, v2
    v_lshl_add_u32 v32, v33, 3, v32
    v_lshlrev_b32 v32, 1, v32
    global_load_ushort v56, v32, s[16:17]
    global_load_ushort v57, v32, s[16:17] offset:8
Lside_b:
    s_cmp_lg_u32 s33, 5
    s_cbranch_scc1 Lside_t
    s_mov_b64 exec, 0xff
    s_lshl_b32 s76, s43, 10
    v_lshl_add_u32 v32, v2, 7, s76
    global_load_dword v15, v32, s[18:19]
    s_mov_b64 exec, -1
Lside_t:
    s_and_b32 s6, s2, 7
    s_sub_u32 s87, 8, s6
    s_lshl_b32 s87, s87, 5
    s_mul_i32 s6, s6, 1291264
    s_mul_i32 s80, s43, 8192
    s_add_u32 s80, s80, 4294909952
    s_add_u32 s80, s80, s6
    s_cmp_ge_u32 s33, 7
    s_cselect_b32 s80, s80, 10240000
    v_add_u32 v194, s80, v14
    buffer_load_dword v15, v194, s[20:23], 0 offen
    v_mov_b32 v152, 0
    v_mov_b32 v153, 0
    v_mov_b32 v154, 0
    v_mov_b32 v155, 0
    v_mov_b32 v156, 0
    v_mov_b32 v157, 0
    v_mov_b32 v158, 0
    v_mov_b32 v159, 0
    v_mov_b32 v160, 0
    v_mov_b32 v161, 0
    v_mov_b32 v162, 0
    v_mov_b32 v163, 0
    v_mov_b32 v164, 0
    v_mov_b32 v165, 0
    v_mov_b32 v166, 0
    v_mov_b32 v167, 0
    v_mov_b32 v168, 0
    v_mov_b32 v169, 0
    v_mov_b32 v170, 0
    v_mov_b32 v171, 0
    v_mov_b32 v172, 0
    v_mov_b32 v173, 0
    v_mov_b32 v174, 0
    v_mov_b32 v175, 0
    v_mov_b32 v176, 0
    v_mov_b32 v177, 0
    v_mov_b32 v178, 0
    v_mov_b32 v179, 0
    v_mov_b32 v180, 0
    v_mov_b32 v181, 0
    v_mov_b32 v182, 0
    v_mov_b32 v183, 0
    v_mov_b32 v184, 0
    v_mov_b32 v185, 0
    v_mov_b32 v186, 0
    v_mov_b32 v187, 0
    v_mov_b32 v188, 0
    v_mov_b32 v189, 0
    v_mov_b32 v190, 0
    v_mov_b32 v191, 0
    v_subrev_u32 v11, 320, v0
    v_subrev_u32 v12, 128, v0
    v_add_u32 v13, 64, v0
    s_cmp_lg_u32 s33, 5
    s_cbranch_scc1 La_notag2
    s_waitcnt vmcnt(2)
    v_add_u32 v195, 0x9e3779b9, v195
    ds_write_b32 v204, v195
    s_waitcnt lgkmcnt(0)
La_notag2:
    s_barrier
    ds_read_b32 v105, v204
    s_cmp_ge_u32 s33, 5
    s_cbranch_scc1 La_side
    v_mov_b32 v104, 0
    v_mov_b32 v106, 0
    s_waitcnt lgkmcnt(0)
    v_readfirstlane_b32 s41, v105
    v_mov_b32 v107, v105
    s_cmp_ge_u32 s33, 2
    s_cbranch_scc1 La_join
    global_store_dwordx4 v38, v[104:107], s[28:29] sc1
    s_branch La_join
La_side:
    v_lshrrev_b32 v32, 5, v11
    v_and_b32 v33, 31, v11
    v_lshlrev_b32 v32, 11, v32
    v_lshl_add_u32 v32, v33, 3, v32
    global_load_dwordx2 v[120:121], v32, s[18:19] offset:0
    global_load_dwordx2 v[122:123], v32, s[18:19] offset:256
    global_load_dwordx2 v[124:125], v32, s[18:19] offset:512
    global_load_dwordx2 v[126:127], v32, s[18:19] offset:768
    global_load_dwordx2 v[128:129], v32, s[18:19] offset:1024
    global_load_dwordx2 v[130:131], v32, s[18:19] offset:1280
    global_load_dwordx2 v[132:133], v32, s[18:19] offset:1536
    global_load_dwordx2 v[134:135], v32, s[18:19] offset:1792
    v_lshrrev_b32 v32, 5, v12
    v_and_b32 v33, 31, v12
    v_lshlrev_b32 v32, 11, v32
    v_lshl_add_u32 v32, v33, 3, v32
    global_load_dwordx2 v[136:137], v32, s[18:19] offset:0
    global_load_dwordx2 v[138:139], v32, s[18:19] offset:256
    global_load_dwordx2 v[140:141], v32, s[18:19] offset:512
    global_load_dwordx2 v[142:143], v32, s[18:19] offset:768
    global_load_dwordx2 v[144:145], v32, s[18:19] offset:1024
    global_load_dwordx2 v[146:147], v32, s[18:19] offset:1280
    global_load_dwordx2 v[148:149], v32, s[18:19] offset:1536
    global_load_dwordx2 v[150:151], v32, s[18:19] offset:1792
    s_waitcnt lgkmcnt(0)
    v_readfirstlane_b32 s41, v105
    s_cmp_eq_u32 s33, 7
    s_cbranch_scc1 La_join
    v_lshrrev_b32 v32, 5, v13
    v_and_b32 v33, 31, v13
    v_lshlrev_b32 v32, 11, v32
    v_lshl_add_u32 v32, v33, 3, v32
    global_load_dwordx2 v[208:209], v32, s[18:19] offset:0
    global_load_dwordx2 v[210:211], v32, s[18:19] offset:256
    global_load_dwordx2 v[212:213], v32, s[18:19] offset:512
    global_load_dwordx2 v[214:215], v32, s[18:19] offset:768
    global_load_dwordx2 v[216:217], v32, s[18:19] offset:1024
    global_load_dwordx2 v[218:219], v32, s[18:19] offset:1280
    global_load_dwordx2 v[220:221], v32, s[18:19] offset:1536
    global_load_dwordx2 v[222:223], v32, s[18:19] offset:1792
    s_branch La_join
Lm_wmside:
    s_mov_b32 s76, 0x05040100
    s_mov_b32 s77, 0x07060302
    s_waitcnt vmcnt(4)
    s_cmp_lt_u32 s2, 250
    s_cbranch_scc1 Lm_wmgo
    s_waitcnt vmcnt(2)
Lm_wmgo:
    v_bfe_u32 v32, v11, 3, 2
    v_lshrrev_b32 v33, 7, v11
    v_lshlrev_b32 v32, 13, v32
    v_lshl_add_u32 v32, v33, 11, v32
    v_bfe_u32 v33, v11, 5, 2
    v_lshl_add_u32 v32, v33, 8, v32
    v_and_b32 v33, 7, v11
    v_lshl_add_u32 v32, v33, 5, v32
    v_perm_b32 v224, v122, v120, s76
    v_perm_b32 v225, v126, v124, s76
    v_perm_b32 v226, v130, v128, s76
    v_perm_b32 v227, v134, v132, s76
    ds_write_b128 v32, v[224:227] offset:5632
    v_perm_b32 v228, v122, v120, s77
    v_perm_b32 v229, v126, v124, s77
    v_perm_b32 v230, v130, v128, s77
    v_perm_b32 v231, v134, v132, s77
    ds_write_b128 v32, v[228:231] offset:6656
    v_perm_b32 v232, v123, v121, s76
    v_perm_b32 v233, v127, v125, s76
    v_perm_b32 v234, v131, v129, s76
    v_perm_b32 v235, v135, v133, s76
    ds_write_b128 v32, v[232:235] offset:5648
    v_perm_b32 v236, v123, v121, s77
    v_perm_b32 v237, v127, v125, s77
    v_perm_b32 v238, v131, v129, s77
    v_perm_b32 v239, v135, v133, s77
    ds_write_b128 v32, v[236:239] offset:6672
    v_bfe_u32 v32, v12, 3, 2
    v_lshrrev_b32 v33, 7, v12
    v_lshlrev_b32 v32, 13, v32
    v_lshl_add_u32 v32, v33, 11, v32
    v_bfe_u32 v33, v12, 5, 2
    v_lshl_add_u32 v32, v33, 8, v32
    v_and_b32 v33, 7, v12
    v_lshl_add_u32 v32, v33, 5, v32
    v_perm_b32 v120, v138, v136, s76
    v_perm_b32 v121, v142, v140, s76
    v_perm_b32 v122, v146, v144, s76
    v_perm_b32 v123, v150, v148, s76
    ds_write_b128 v32, v[120:123] offset:5632
    v_perm_b32 v124, v138, v136, s77
    v_perm_b32 v125, v142, v140, s77
    v_perm_b32 v126, v146, v144, s77
    v_perm_b32 v127, v150, v148, s77
    ds_write_b128 v32, v[124:127] offset:6656
    v_perm_b32 v128, v139, v137, s76
    v_perm_b32 v129, v143, v141, s76
    v_perm_b32 v130, v147, v145, s76
    v_perm_b32 v131, v151, v149, s76
    ds_write_b128 v32, v[128:131] offset:5648
    v_perm_b32 v132, v139, v137, s77
    v_perm_b32 v133, v143, v141, s77
    v_perm_b32 v134, v147, v145, s77
    v_perm_b32 v135, v151, v149, s77
    ds_write_b128 v32, v[132:135] offset:6672
    s_cmp_lg_u32 s33, 7
    s_cbranch_scc1 Lside_c
    s_mov_b32 s40, 0xbfb8aa3b
    v_lshlrev_b32 v60, 16, v56
    v_and_b32 v64, 0xffff0000, v56
    v_lshlrev_b32 v61, 16, v57
    v_and_b32 v65, 0xffff0000, v57
    v_lshlrev_b32 v62, 16, v58
    v_and_b32 v66, 0xffff0000, v58
    v_lshlrev_b32 v63, 16, v59
    v_and_b32 v67, 0xffff0000, v59
    v_mul_f32 v60, s40, v60
    v_mul_f32 v61, s40, v61
    v_mul_f32 v62, s40, v62
    v_mul_f32 v63, s40, v63
    v_mul_f32 v64, s40, v64
    v_mul_f32 v65, s40, v65
    v_mul_f32 v66, s40, v66
    v_mul_f32 v67, s40, v67
    v_cvt_pk_bf16_f32 v72, v60, v61
    v_lshlrev_b32 v32, 16, v72
    v_and_b32 v33, 0xffff0000, v72
    v_sub_f32 v32, v60, v32
    v_sub_f32 v33, v61, v33
    v_cvt_pk_bf16_f32 v74, v32, v33
    v_cvt_pk_bf16_f32 v73, v62, v63
    v_lshlrev_b32 v32, 16, v73
    v_and_b32 v33, 0xffff0000, v73
    v_sub_f32 v32, v62, v32
    v_sub_f32 v33, v63, v33
    v_cvt_pk_bf16_f32 v75, v32, v33
    v_cvt_pk_bf16_f32 v76, v64, v65
    v_lshlrev_b32 v32, 16, v76
    v_and_b32 v33, 0xffff0000, v76
    v_sub_f32 v32, v64, v32
    v_sub_f32 v33, v65, v33
    v_cvt_pk_bf16_f32 v78, v32, v33
    v_cvt_pk_bf16_f32 v77, v66, v67
    v_lshlrev_b32 v32, 16, v77
    v_and_b32 v33, 0xffff0000, v77
    v_sub_f32 v32, v66, v32
    v_sub_f32 v33, v67, v33
    v_cvt_pk_bf16_f32 v79, v32, v33
    ds_write_b128 v1, v[72:75] offset:3584
    ds_write_b128 v1, v[76:79] offset:4608
Lside_c:
    s_cmp_lg_u32 s33, 6
    s_cbranch_scc1 Lside_d
    v_lshl_or_b32 v56, v57, 16, v56
    v_lshlrev_b32 v32, 2, v2
    ds_write_b32 v32, v56 offset:3328
    v_mov_b32 v32, 10240000
    v_mov_b32 v33, 528
    v_mov_b32 v34, 0
    ds_write_b64 v34, v[32:33] offset:544
Lside_d:
    s_cmp_eq_u32 s33, 7
    s_cbranch_scc1 Lm_wmback
    v_bfe_u32 v32, v13, 3, 2
    v_lshrrev_b32 v33, 7, v13
    v_lshlrev_b32 v32, 13, v32
    v_lshl_add_u32 v32, v33, 11, v32
    v_bfe_u32 v33, v13, 5, 2
    v_lshl_add_u32 v32, v33, 8, v32
    v_and_b32 v33, 7, v13
    v_lshl_add_u32 v32, v33, 5, v32
    v_perm_b32 v136, v210, v208, s76
    v_perm_b32 v137, v214, v212, s76
    v_perm_b32 v138, v218, v216, s76
    v_perm_b32 v139, v222, v220, s76
    ds_write_b128 v32, v[136:139] offset:5632
    v_perm_b32 v140, v210, v208, s77
    v_perm_b32 v141, v214, v212, s77
    v_perm_b32 v142, v218, v216, s77
    v_perm_b32 v143, v222, v220, s77
    ds_write_b128 v32, v[140:143] offset:6656
    v_perm_b32 v144, v211, v209, s76
    v_perm_b32 v145, v215, v213, s76
    v_perm_b32 v146, v219, v217, s76
    v_perm_b32 v147, v223, v221, s76
    ds_write_b128 v32, v[144:147] offset:5648
    v_perm_b32 v148, v211, v209, s77
    v_perm_b32 v149, v215, v213, s77
    v_perm_b32 v150, v219, v217, s77
    v_perm_b32 v151, v223, v221, s77
    ds_write_b128 v32, v[148:151] offset:6672
    s_branch Lm_wmback
Lm_ldx:
    s_mov_b64 exec, s[68:69]
    s_cbranch_execz Lm_ld
    s_mov_b64 exec, -1
    v_cmp_lt_i32 s[70:71], 10, v5
    v_cmp_lt_i32 s[72:73], 12, v5
    v_cmp_lt_i32 s[74:75], 14, v5
    s_mov_b64 exec, s[68:69]
    global_load_dwordx4 v[104:107], v4, s[30:31] offset:128 sc1
    s_mov_b64 exec, s[70:71]
    s_cbranch_execz Lm_ld
    global_load_dwordx4 v[108:111], v4, s[30:31] offset:160 sc1
    s_mov_b64 exec, s[72:73]
    s_cbranch_execz Lm_ld
    global_load_dwordx4 v[112:115], v4, s[30:31] offset:192 sc1
    s_mov_b64 exec, s[74:75]
    s_cbranch_execz Lm_ld
    global_load_dwordx4 v[116:119], v4, s[30:31] offset:224 sc1
    s_branch Lm_ld
Lm_ck0x:
    s_mov_b64 exec, s[68:69]
    s_cbranch_execz Lm_ck0
    v_cmp_ne_u32 vcc, s41, v105
    v_and_b32 v132, 63, v104
    v_lshlrev_b32 v132, 2, v132
    s_or_b64 s[8:9], s[8:9], vcc
    s_mov_b64 exec, s[70:71]
    s_cbranch_execz Lm_ck0
    v_cmp_ne_u32 vcc, s41, v109
    v_and_b32 v133, 63, v108
    v_lshlrev_b32 v133, 2, v133
    s_or_b64 s[8:9], s[8:9], vcc
    s_mov_b64 exec, s[72:73]
    s_cbranch_execz Lm_ck0
    v_cmp_ne_u32 vcc, s41, v113
    v_and_b32 v134, 63, v112
    v_lshlrev_b32 v134, 2, v134
    s_or_b64 s[8:9], s[8:9], vcc
    s_mov_b64 exec, s[74:75]
    s_cbranch_execz Lm_ck0
    v_cmp_ne_u32 vcc, s41, v117
    v_and_b32 v135, 63, v116
    v_lshlrev_b32 v135, 2, v135
    s_or_b64 s[8:9], s[8:9], vcc
    s_branch Lm_ck0
Lm_h1x:
    s_mov_b64 exec, s[68:69]
    s_cbranch_execz Lm_h1
    ds_add_u32 v132, v6 offset:0
    global_load_dwordx3 v[72:74], v192, s[30:31] offset:128 sc1
    ds_write_b64 v3, v[106:107] offset:32768
    v_lshrrev_b32 v140, 22, v104
    v_add_u32 v140, s87, v140
    v_and_b32 v104, 0x00fffc00, v104
    s_mov_b64 exec, s[70:71]
    s_cbranch_execz Lm_h1
    ds_add_u32 v133, v6 offset:0
    global_load_dwordx3 v[76:78], v192, s[30:31] offset:160 sc1
    ds_write_b64 v3, v[110:111] offset:40960
    v_lshrrev_b32 v141, 22, v108
    v_add_u32 v141, s87, v141
    v_and_b32 v108, 0x00fffc00, v108
    s_mov_b64 exec, s[72:73]
    s_cbranch_execz Lm_h1
    ds_add_u32 v134, v6 offset:0
    global_load_dwordx3 v[80:82], v192, s[30:31] offset:192 sc1
    ds_write_b64 v3, v[114:115] offset:49152
    v_lshrrev_b32 v142, 22, v112
    v_add_u32 v142, s87, v142
    v_and_b32 v112, 0x00fffc00, v112
    s_mov_b64 exec, s[74:75]
    s_cbranch_execz Lm_h1
    ds_add_u32 v135, v6 offset:0
    global_load_dwordx3 v[84:86], v192, s[30:31] offset:224 sc1
    ds_write_b64 v3, v[118:119] offset:57344
    v_lshrrev_b32 v143, 22, v116
    v_add_u32 v143, s87, v143
    v_and_b32 v116, 0x00fffc00, v116
    s_branch Lm_h1
Lm_mpx:
    s_mov_b64 exec, s[68:69]
    s_cbranch_execz Lm_mp
    ds_read_b32 v148, v132 offset:768
    s_mov_b64 exec, s[70:71]
    s_cbranch_execz Lm_mp
    ds_read_b32 v149, v133 offset:768
    s_mov_b64 exec, s[72:73]
    s_cbranch_execz Lm_mp
    ds_read_b32 v150, v134 offset:768
    s_mov_b64 exec, s[74:75]
    s_cbranch_execz Lm_mp
    ds_read_b32 v151, v135 offset:768
    s_branch Lm_mp
Lm_sbx:
    ds_bpermute_b32 v140, v140, v193
    ds_bpermute_b32 v141, v141, v193
    ds_bpermute_b32 v142, v142, v193
    ds_bpermute_b32 v143, v143, v193
    s_branch Lm_sb
Lm_h2x:
    s_mov_b64 exec, s[68:69]
    s_cbranch_execz Lm_h2
    v_lshrrev_b32 v140, v148, v140
    v_and_b32 v132, 0xe0, v148
    v_and_or_b32 v132, v140, 28, v132
    ds_add_rtn_u32 v140, v132, v6 offset:256
    v_bfe_u32 v148, v148, 16, 8
    v_or_b32 v104, v104, v148
    v_add_u32 v105, 32768, v3
    s_mov_b64 exec, s[70:71]
    s_cbranch_execz Lm_h2
    v_lshrrev_b32 v141, v149, v141
    v_and_b32 v133, 0xe0, v149
    v_and_or_b32 v133, v141, 28, v133
    ds_add_rtn_u32 v141, v133, v6 offset:256
    v_bfe_u32 v149, v149, 16, 8
    v_or_b32 v108, v108, v149
    v_add_u32 v109, 40960, v3
    s_mov_b64 exec, s[72:73]
    s_cbranch_execz Lm_h2
    v_lshrrev_b32 v142, v150, v142
    v_and_b32 v134, 0xe0, v150
    v_and_or_b32 v134, v142, 28, v134
    ds_add_rtn_u32 v142, v134, v6 offset:256
    v_bfe_u32 v150, v150, 16, 8
    v_or_b32 v112, v112, v150
    v_add_u32 v113, 49152, v3
    s_mov_b64 exec, s[74:75]
    s_cbranch_execz Lm_h2
    v_lshrrev_b32 v143, v151, v143
    v_and_b32 v135, 0xe0, v151
    v_and_or_b32 v135, v143, 28, v135
    ds_add_rtn_u32 v143, v135, v6 offset:256
    v_bfe_u32 v151, v151, 16, 8
    v_or_b32 v116, v116, v151
    v_add_u32 v117, 57344, v3
    s_branch Lm_h2
Lm_bpx:
    ds_bpermute_b32 v148, v132, v32
    ds_bpermute_b32 v149, v133, v32
    ds_bpermute_b32 v150, v134, v32
    ds_bpermute_b32 v151, v135, v32
    s_branch Lm_bp
Lm_g1w:
    s_waitcnt vmcnt(0)
    s_branch Lm_g1
Lm_ck1x:
    s_mov_b64 exec, s[68:69]
    s_cbranch_execz Lm_ck1
    v_cmp_ne_u32 vcc, s41, v74
    ds_write_b64 v3, v[72:73] offset:32776
    s_or_b64 s[8:9], s[8:9], vcc
    s_mov_b64 exec, s[70:71]
    s_cbranch_execz Lm_ck1
    v_cmp_ne_u32 vcc, s41, v78
    ds_write_b64 v3, v[76:77] offset:40968
    s_or_b64 s[8:9], s[8:9], vcc
    s_mov_b64 exec, s[72:73]
    s_cbranch_execz Lm_ck1
    v_cmp_ne_u32 vcc, s41, v82
    ds_write_b64 v3, v[80:81] offset:49160
    s_or_b64 s[8:9], s[8:9], vcc
    s_mov_b64 exec, s[74:75]
    s_cbranch_execz Lm_ck1
    v_cmp_ne_u32 vcc, s41, v86
    ds_write_b64 v3, v[84:85] offset:57352
    s_or_b64 s[8:9], s[8:9], vcc
    s_branch Lm_ck1
Lm_wrx:
    s_mov_b64 exec, s[68:69]
    s_cbranch_execz Lm_wr
    v_add_u32 v140, v140, v148
    v_lshl_add_u32 v140, v140, 3, s78
    ds_write_b64 v140, v[104:105]
    s_mov_b64 exec, s[70:71]
    s_cbranch_execz Lm_wr
    v_add_u32 v141, v141, v149
    v_lshl_add_u32 v141, v141, 3, s78
    ds_write_b64 v141, v[108:109]
    s_mov_b64 exec, s[72:73]
    s_cbranch_execz Lm_wr
    v_add_u32 v142, v142, v150
    v_lshl_add_u32 v142, v142, 3, s78
    ds_write_b64 v142, v[112:113]
    s_mov_b64 exec, s[74:75]
    s_cbranch_execz Lm_wr
    v_add_u32 v143, v143, v151
    v_lshl_add_u32 v143, v143, 3, s78
    ds_write_b64 v143, v[116:117]
    s_branch Lm_wr
Lm_next:
    s_setprio 0
    s_waitcnt vmcnt(0) lgkmcnt(0)
    s_barrier
    v_subrev_u32 v5, 16, v5
    v_add_u32 v4, 256, v4
    s_branch Lm_round
Lm_big:
    s_waitcnt lgkmcnt(0)
    s_barrier
    s_branch Lm_small
Lm_re0:
    s_sub_u32 s3, s3, 1
    s_cbranch_scc0 Lm_g0
    s_endpgm
Lm_re1:
    s_sub_u32 s3, s3, 1
    s_cbranch_scc1 Lm_end
    s_mov_b64 exec, s[60:61]
    s_cbranch_execz Lm_rl1
    global_load_dwordx3 v[56:58], v192, s[30:31] offset:0 sc1
    s_mov_b64 exec, s[62:63]
    s_cbranch_execz Lm_rl1
    global_load_dwordx3 v[60:62], v192, s[30:31] offset:32 sc1
    s_mov_b64 exec, s[64:65]
    s_cbranch_execz Lm_rl1
    global_load_dwordx3 v[64:66], v192, s[30:31] offset:64 sc1
    s_mov_b64 exec, s[66:67]
    s_cbranch_execz Lm_rl1
    global_load_dwordx3 v[68:70], v192, s[30:31] offset:96 sc1
    s_mov_b64 exec, s[68:69]
    s_cbranch_execz Lm_rl1
    global_load_dwordx3 v[72:74], v192, s[30:31] offset:128 sc1
    s_mov_b64 exec, s[70:71]
    s_cbranch_execz Lm_rl1
    global_load_dwordx3 v[76:78], v192, s[30:31] offset:160 sc1
    s_mov_b64 exec, s[72:73]
    s_cbranch_execz Lm_rl1
    global_load_dwordx3 v[80:82], v192, s[30:31] offset:192 sc1
    s_mov_b64 exec, s[74:75]
    s_cbranch_execz Lm_rl1
    global_load_dwordx3 v[84:86], v192, s[30:31] offset:224 sc1
Lm_rl1:
    s_mov_b64 exec, -1
    s_mov_b64 s[8:9], 0
    s_waitcnt vmcnt(0) lgkmcnt(0)
    s_branch Lm_g1
.p2align 2
.type tfn_deal_table,@object
tfn_deal_table:
.long 0x980000c9, 0x940000a9, 0x9c0000e9, 0x700809e6, 0x90000989, 0x500812a6, 0x600812c6, 0x80001209
.long 0x741000e6, 0x88000049, 0x8c000069, 0x781800e6, 0x40080086, 0x84000029, 0x44100086, 0x10080926
.long 0x20080946, 0x80906, 0x48180986, 0x30080966, 0x14100926, 0x541009a6, 0x34101266, 0x24101246
.long 0x641012c6, 0x38181266, 0x4101206, 0x681812c6, 0x581812a6, 0x28181b46, 0x18181b26, 0x8181b06
.long 0xc201b06, 0x1c201b26, 0x2c201b46, 0x3c201b66, 0x4c202486, 0x5c2024a6, 0x6c2024c6, 0x7c2024e6
.long 0x2400, 0x2400, 0x2400, 0x2d00, 0x2d00, 0x2d00, 0x2d00, 0x2d00
.long 0x2d00, 0x2d00, 0x3600, 0x3600, 0x3600, 0x3600, 0x3600, 0x3600
.long 0x3600, 0x3f00, 0x3f00, 0x3f00, 0x3f00, 0x3f00, 0x3f00, 0x3f00
.long 0x980000c9, 0x9c0000e9, 0x88000049, 0x940009a9, 0x90000989, 0x700812e6, 0x600812c6, 0x500812a6
.long 0x8c000069, 0x40080086, 0x541000a6, 0x80000009, 0x30080066, 0x84000029, 0x741000e6, 0x44100986
.long 0x80906, 0x10080926, 0x20080946, 0x14100926, 0x4100906, 0x641009c6, 0x24101246, 0x48181286
.long 0x34101266, 0x781812e6, 0x581812a6, 0x18181226, 0x681812c6, 0x38181b66, 0x8181b06, 0x4c201b86
.long 0xc201b06, 0x1c201b26, 0x28181b46, 0x3c201b66, 0x2c202446, 0x5c2024a6, 0x6c2024c6, 0x7c2024e6
.long 0x2400, 0x2400, 0x2400, 0x2d00, 0x2d00, 0x2d00, 0x2d00, 0x2d00
.long 0x2d00, 0x2d00, 0x3600, 0x3600, 0x3600, 0x3600, 0x3600, 0x3600
.long 0x3600, 0x3f00, 0x3f00, 0x3f00, 0x3f00, 0x3f00, 0x3f00, 0x3f00
.size tfn_deal_table, 512
.section .rodata,"a"
.p2align 6
.amdhsa_kernel gather_scatter__tensor_product_equiv_tfn__graph_kernel
.amdhsa_next_free_vgpr 256
.amdhsa_next_free_sgpr 102
.amdhsa_accum_offset 256
.amdhsa_group_segment_fixed_size 0
.amdhsa_kernarg_size 88
.amdhsa_user_sgpr_count 2
.amdhsa_user_sgpr_kernarg_segment_ptr 1
.amdhsa_system_sgpr_workgroup_id_x 1
.amdhsa_float_denorm_mode_32 3
.end_amdhsa_kernel
```
